```python
import torch

def _softmax(x, axis=-1):
    return torch.softmax(x, dim=axis)

def _gelu(x):
    return torch.nn.functional.gelu(x, approximate='tanh')

def _silu(x):
    return torch.nn.functional.silu(x)

def _sigmoid(x):
    return torch.sigmoid(x)

def _layernorm(x, axis=-1, eps=1e-05):
    m = x.mean(dim=axis, keepdim=True)
    v = x.var(dim=axis, keepdim=True, unbiased=False)
    return (x - m) / torch.sqrt(v + eps)

def _scatter_add(tgt, idx, src, axis=0):
    return tgt.clone().index_add_(axis, idx, src)

def _segment_sum(src, seg, n):
    out = torch.zeros((n,) + src.shape[1:], dtype=src.dtype)
    return out.index_add_(0, seg, src)

def _pad(x, pw):
    flat = tuple((v for pair in reversed(pw) for v in pair))
    return torch.nn.functional.pad(x, flat)
kernel_name = 'adaLN_cond__ssm_conv_s4d__glu_gated_geglu__prompt'

def setup_inputs():

    _w = lambda a: (lambda t: t.to(torch.bfloat16) if t.is_floating_point() else t)(torch.as_tensor(a))

    def _A_setup():
        Bsz, L, D, N = (1, 2048, 512, 128)
        return {'u': _w((lambda *s: torch.randn(*s, dtype=torch.bfloat16) * 0.05)(Bsz, L, D)), 'log_A_real': _w((lambda *s: torch.randn(*s, dtype=torch.bfloat16) * 3.2)(D, N) * 0.5), 'A_imag': _w((lambda *s: torch.randn(*s, dtype=torch.bfloat16) * 0.1)(D, N) * 3.14), 'C_real': _w((lambda *s: torch.randn(*s, dtype=torch.bfloat16) * 0.2)(D, N) / N ** 0.5), 'C_imag': _w((lambda *s: torch.randn(*s, dtype=torch.bfloat16) * 0.2)(D, N) / N ** 0.5), 'log_dt': _w((lambda *s: torch.randn(*s, dtype=torch.bfloat16) * 0.1)(D) * 0.5 - 4.0), 'D_skip': _w((lambda *s: torch.randn(*s, dtype=torch.bfloat16) * 0.1)(D))}
    _A_in = _A_setup()

    def _B_setup():
        B, S, Dm, Df = (1, 2048, 512, 1792)
        return {'x': _w((lambda *s: torch.randn(*s, dtype=torch.bfloat16) * 0.05)(B, S, Dm)), 'w_gate': _w((lambda *s: torch.randn(*s, dtype=torch.bfloat16) * 1.6)(Dm, Df) * Dm ** (-0.5)), 'w_up': _w((lambda *s: torch.randn(*s, dtype=torch.bfloat16) * 1.6)(Dm, Df) * Dm ** (-0.5)), 'w_down': _w((lambda *s: torch.randn(*s, dtype=torch.bfloat16) * 1.6)(Df, Dm) * Df ** (-0.5))}
    _B_in = _B_setup()
    return {'A_u': _A_in['u'], 'A_log_A_real': _A_in['log_A_real'], 'A_A_imag': _A_in['A_imag'], 'A_C_real': _A_in['C_real'], 'A_C_imag': _A_in['C_imag'], 'A_log_dt': _A_in['log_dt'], 'A_D_skip': _A_in['D_skip'], 'B_x': _B_in['x'], 'B_w_gate': _B_in['w_gate'], 'B_w_up': _B_in['w_up'], 'B_w_down': _B_in['w_down'], 'c': _w((lambda *s: torch.randn(*s, dtype=torch.bfloat16) * 0.2)(1, 512) * 8.0), 'w_mod': _w((lambda *s: torch.randn(*s, dtype=torch.bfloat16) * 0.2)(512, 6 * 512) * 512 ** (-0.5) * 8.0)}

def reference(A_u, A_log_A_real, A_A_imag, A_C_real, A_C_imag, A_log_dt, A_D_skip, B_x, B_w_gate, B_w_up, B_w_down, c, w_mod):

    def _A_ref(u, log_A_real, A_imag, C_real, C_imag, log_dt, D_skip):
        L = u.shape[1]
        dt = torch.exp(log_dt)
        A = -torch.exp(log_A_real) + 1j * A_imag
        C = (C_real + 1j * C_imag) * dt[:, None]
        pos = (lambda x, dt: x.to(dt))(torch.arange(L), log_dt.dtype)
        P = torch.exp((A * dt[:, None])[:, :, None] * pos[None, None, :])
        K = 2.0 * torch.einsum('dn,dnl->dl', C, P).real
        L2 = 2 * L
        u_t = (lambda x, *d: x.permute(*d))(u, 0, 2, 1)
        Kf = (lambda x, *a, **k: torch.fft.rfft(x.float(), *a, **k))(K, L2)
        Uf = (lambda x, *a, **k: torch.fft.rfft(x.float(), *a, **k))(u_t, L2)
        y = (lambda x, *a, **k: torch.fft.irfft(x, *a, **k).to(torch.bfloat16))(Uf * Kf[None, :, :], L2)[:, :, :L]
        y = (lambda x, *d: x.permute(*d))(y, 0, 2, 1)
        return y + u * D_skip[None, None, :]

    def _B_ref(x, w_gate, w_up, w_down):
        g = torch.einsum('bsd,df->bsf', x, w_gate)
        u = torch.einsum('bsd,df->bsf', x, w_up)
        h = _gelu(g) * u
        return torch.einsum('bsf,fd->bsd', h, w_down)
    x = A_u
    mod = (_silu(c) @ w_mod).reshape(c.shape[0], 6, 1, -1)
    sa, ca, ga, sb, cb, gb = (mod[:, 0].clone(), mod[:, 1].clone(), mod[:, 2].clone(), mod[:, 3].clone(), mod[:, 4].clone(), mod[:, 5].clone())
    h = _layernorm(x, axis=-1) * (1 + ca) + sa
    x = x + ga * _A_ref(h, A_log_A_real, A_A_imag, A_C_real, A_C_imag, A_log_dt, A_D_skip)
    h = _layernorm(x, axis=-1) * (1 + cb) + sb
    x = x + gb * _B_ref(h, B_w_gate, B_w_up, B_w_down)
    return x
```

```asm
; @launch kernel=prep_kernel grid=(480,1,1) block=(256,1,1) lds=67584
; @launch kernel=conv_kernel grid=(256,1,1) block=(512,1,1) lds=124928
; @launch kernel=ffn_kernel grid=(256,1,1) block=(512,1,1) lds=157696
.amdgcn_target "amdgcn-amd-amdhsa--gfx950"
.text
.globl prep_kernel
.p2align 8
.type prep_kernel,@function
prep_kernel:
    s_getpc_b64 s[88:89]
    s_load_dwordx16 s[16:31], s[0:1], 0
    s_load_dwordx16 s[32:47], s[0:1], 64
    s_lshr_b32 s87, s2, 3
    s_and_b32 s87, s87, 15
    s_lshl_b32 s87, s87, 12
    v_lshl_add_u32 v200, v0, 4, s87
    v_min_u32 v200, code_end-prep_kernel-32, v200
    global_load_dwordx4 v[196:199], v200, s[88:89]
    s_cmp_ge_u32 s2, 480
    s_cbranch_scc1 prep_kernel_end3
    v_and_b32 v4, 63, v0
    v_lshrrev_b32 v5, 6, v0
    s_nop 0
    v_readfirstlane_b32 s50, v5
    s_cmp_lt_u32 s2, 256
    s_cbranch_scc1 prep_kernel_kg6
    s_cmp_lt_u32 s2, 352
    s_cbranch_scc1 prep_kernel_mod1
prep_kernel_st2:
    s_sub_u32 s3, s2, 352
    s_lshl_b32 s3, s3, 4
    v_lshrrev_b32 v15, 4, v0
    v_add_u32 v1, s3, v15
    v_and_b32 v2, 15, v0
    v_lshlrev_b32 v3, 10, v1
    v_lshl_add_u32 v3, v2, 4, v3
    s_mov_b32 s60, 0x3f803f80
    v_mul_u32_u24 v14, 272, v2
    v_lshl_add_u32 v14, v15, 2, v14
    s_waitcnt lgkmcnt(0)
    global_load_dwordx4 v[16:19], v3, s[16:17] offset:0
    global_load_dwordx4 v[20:23], v3, s[16:17] offset:256
    global_load_dwordx4 v[24:27], v3, s[16:17] offset:512
    global_load_dwordx4 v[28:31], v3, s[16:17] offset:768
    s_branch prep_kernel_st2_2
prep_kernel_mod1:
    s_sub_u32 s3, s2, 256
    s_lshl_b32 s3, s3, 2
    s_add_u32 s3, s3, s50
    s_mul_i32 s4, s3, 1366
    s_lshr_b32 s4, s4, 16
    s_mul_i32 s5, s4, 48
    s_sub_u32 s5, s3, s5
    v_and_b32 v2, 7, v4
    v_lshrrev_b32 v3, 3, v4
    s_lshl_b32 s6, s4, 7
    v_lshl_add_u32 v1, v4, 1, s6
    s_mul_i32 s6, s4, 393216
    s_lshl_b32 s7, s5, 7
    s_add_u32 s6, s6, s7
    v_mul_u32_u24 v5, 6144, v3
    v_lshl_add_u32 v5, v2, 4, v5
    v_add_u32 v5, s6, v5
    s_waitcnt lgkmcnt(0)
    global_load_ushort v6, v1, s[38:39]
    global_load_dwordx4 v[16:19], v5, s[40:41]
    v_add_u32 v5, 49152, v5
    global_load_dwordx4 v[20:23], v5, s[40:41]
    v_add_u32 v5, 49152, v5
    global_load_dwordx4 v[24:27], v5, s[40:41]
    v_add_u32 v5, 49152, v5
    global_load_dwordx4 v[28:31], v5, s[40:41]
    v_add_u32 v5, 49152, v5
    global_load_dwordx4 v[32:35], v5, s[40:41]
    v_add_u32 v5, 49152, v5
    global_load_dwordx4 v[36:39], v5, s[40:41]
    v_add_u32 v5, 49152, v5
    global_load_dwordx4 v[40:43], v5, s[40:41]
    v_add_u32 v5, 49152, v5
    global_load_dwordx4 v[44:47], v5, s[40:41]
    s_branch prep_kernel_mod1_2
prep_kernel_kg6:
    s_lshr_b32 s56, s50, 1
    s_and_b32 s57, s50, 1
    s_lshl_b32 s48, s2, 1
    s_add_u32 s48, s48, s56
    v_and_b32 v0, 127, v0
    s_lshl_b32 s4, s48, 1
    s_lshl_b32 s3, s48, 8
    v_lshl_add_u32 v1, v4, 2, s3
    v_mov_b32 v6, s4
    s_mov_b32 s60, 0x3fb8aa3b
    s_mov_b32 s61, 0x32a57060
    s_mov_b32 s62, 0x3f317218
    s_mul_i32 s63, s56, 33792
    s_waitcnt lgkmcnt(0)
    global_load_ushort v7, v6, s[26:27]
    global_load_dword v2, v1, s[18:19]
    global_load_dword v3, v1, s[20:21]
    global_load_dword v10, v1, s[22:23]
    global_load_dword v11, v1, s[24:25]
    s_lshl_b32 s4, s50, 6
    v_add_u32 v0, s4, v4
    v_and_b32 v0, 127, v0
    s_mov_b32 s8, s46
    s_mov_b32 s9, s47
    s_mov_b32 s10, 0x15c0000
    s_mov_b32 s11, 0x20000
    v_and_b32 v60, 15, v4
    v_lshrrev_b32 v61, 4, v4
    s_lshl_b32 s4, s57, 4
    v_lshlrev_b32 v63, 2, v61
    v_add_u32 v63, s4, v63
    v_mov_b32 v64, 2
    v_bfe_u32 v65, v60, 1, 1
    v_lshlrev_b32 v65, 6, v65
    v_and_b32 v66, 1, v60
    v_add3_u32 v65, v65, v66, 0
    v_add_u32 v65, 384, v65
    v_cmp_gt_u32 vcc, 12, v60
    v_add_u32 v66, 248, v60
    s_nop 0
    v_cndmask_b32 v64, v64, 4, vcc
    v_cndmask_b32 v65, v65, v66, vcc
    v_cmp_gt_u32 vcc, 8, v60
    s_nop 1
    v_cndmask_b32 v64, v64, 8, vcc
    v_cndmask_b32 v65, v65, v60, vcc
    s_add_u32 s64, s63, 28000
    v_mad_u32_u24 v65, v64, v63, v65
    v_lshlrev_b32 v65, 1, v65
    v_add_u32 v65, s64, v65
    v_lshlrev_b32 v64, 1, v64
    v_add_u32 v66, v65, v64
    v_add_u32 v67, v66, v64
    v_add_u32 v68, v67, v64
    v_min_u32 v69, 5, v60
    v_lshl_add_u32 v69, v69, 5, v63
    v_lshlrev_b32 v69, 1, v69
    v_add_u32 v69, s64, v69
    v_add_u32 v70, s4, v60
    v_mul_u32_u24 v70, 528, v70
    v_lshl_add_u32 v70, v61, 4, v70
    v_add_u32 v70, s63, v70
    v_mul_u32_u24 v71, 528, v60
    v_lshl_add_u32 v71, v61, 4, v71
    v_add_u32 v71, s63, v71
    v_lshlrev_b32 v72, 3, v4
    v_add_u32 v72, s63, v72
    s_waitcnt vmcnt(3)
    v_lshlrev_b32 v7, 16, v7
    v_lshlrev_b32 v5, 16, v2
    v_and_b32 v6, 0xffff0000, v2
    v_mul_f32 v12, s60, v7
    v_fma_f32 v13, v7, s60, -v12
    v_fma_f32 v13, v7, s61, v13
    v_exp_f32 v8, v12
    v_mul_f32 v13, s62, v13
    v_fma_f32 v8, v8, v13, v8
    v_cvt_pk_bf16_f32 v8, v8, v8
    v_and_b32 v8, 0xffff0000, v8
    v_mul_f32 v14, s60, v5
    v_fma_f32 v15, v5, s60, -v14
    v_fma_f32 v15, v5, s61, v15
    v_exp_f32 v5, v14
    v_mul_f32 v15, s62, v15
    v_fma_f32 v5, v5, v15, v5
    v_cvt_pk_bf16_f32 v5, v5, v5
    v_and_b32 v5, 0xffff0000, v5
    v_mul_f32 v16, s60, v6
    v_fma_f32 v17, v6, s60, -v16
    v_fma_f32 v17, v6, s61, v17
    v_exp_f32 v6, v16
    v_mul_f32 v17, s62, v17
    v_fma_f32 v6, v6, v17, v6
    v_cvt_pk_bf16_f32 v6, v6, v6
    v_and_b32 v6, 0xffff0000, v6
    s_waitcnt vmcnt(2)
    v_lshlrev_b32 v2, 16, v3
    v_and_b32 v3, 0xffff0000, v3
    v_mul_f32 v5, v5, v8
    v_mul_f32 v5, s60, v5
    v_mul_f32 v6, v6, v8
    v_mul_f32 v6, s60, v6
    v_mul_f32 v2, v2, v8
    v_mul_f32 v2, 0.15915494, v2
    v_mul_f32 v3, v3, v8
    v_mul_f32 v3, 0.15915494, v3
    s_lshl_b32 s4, s50, 6
    v_add_u32 v200, s4, v4
    v_lshrrev_b32 v201, 3, v200
    s_lshr_b32 s85, s2, 3
    s_mul_i32 s85, s85, 56
    v_add_u32 v201, s85, v201
    v_and_b32 v200, 7, v200
    s_and_b32 s84, s2, 7
    s_lshl_b32 s84, s84, 7
    v_lshl_add_u32 v200, v200, 4, s84
    v_lshl_add_u32 v202, v201, 10, v200
    global_load_dwordx4 v[196:199], v202, s[36:37]
    v_add_u32 v201, 32, v201
    v_min_u32 v201, 1791, v201
    v_lshl_add_u32 v202, v201, 10, v200
    global_load_dwordx4 v[196:199], v202, s[36:37]
    s_cmp_eq_u32 s57, 1
    s_cbranch_scc1 prep_kernel_B4
    v_mul_f32 v12, -8.0, v5
    v_mul_f32 v13, 8.0, v2
    v_exp_f32 v12, v12
    v_fract_f32 v13, v13
    v_cos_f32 v14, v13
    v_sin_f32 v15, v13
    v_mul_f32 v16, -8.0, v6
    v_mul_f32 v17, 8.0, v3
    v_exp_f32 v16, v16
    v_fract_f32 v17, v17
    v_cos_f32 v18, v17
    v_sin_f32 v19, v17
    v_mul_f32 v24, v12, v14
    v_mul_f32 v25, v12, v15
    v_mul_f32 v26, v16, v18
    v_mul_f32 v27, v16, v19
    v_mul_f32 v12, -128.0, v5
    v_mul_f32 v13, 128.0, v2
    v_exp_f32 v12, v12
    v_fract_f32 v13, v13
    v_cos_f32 v14, v13
    v_sin_f32 v15, v13
    v_mul_f32 v16, -128.0, v6
    v_mul_f32 v17, 128.0, v3
    v_exp_f32 v16, v16
    v_fract_f32 v17, v17
    v_cos_f32 v18, v17
    v_sin_f32 v19, v17
    v_mul_f32 v28, v12, v14
    v_mul_f32 v29, v12, v15
    v_mul_f32 v30, v16, v18
    v_mul_f32 v31, v16, v19
    s_waitcnt vmcnt(2)
    v_add_f32 v8, v8, v8
    v_lshlrev_b32 v20, 16, v10
    v_lshlrev_b32 v21, 16, v11
    v_and_b32 v22, 0xffff0000, v10
    v_and_b32 v23, 0xffff0000, v11
    v_mul_f32 v9, 0.5, v8
    v_mul_f32 v20, v20, v9
    v_add_f32 v20, v20, v20
    v_mul_f32 v21, v21, v9
    v_add_f32 v21, v21, v21
    v_mul_f32 v22, v22, v9
    v_add_f32 v22, v22, v22
    v_mul_f32 v23, v23, v9
    v_add_f32 v23, v23, v23
    v_pk_mul_f32 v[36:37], v[20:21], v[28:29] op_sel:[0,0] op_sel_hi:[1,0]
    v_pk_mul_f32 v[38:39], v[22:23], v[30:31] op_sel:[0,0] op_sel_hi:[1,0]
    v_pk_fma_f32 v[32:33], v[20:21], v[28:29], v[36:37] op_sel:[1,1,0] op_sel_hi:[0,1,1] neg_lo:[0,1,0]
    v_pk_fma_f32 v[34:35], v[22:23], v[30:31], v[38:39] op_sel:[1,1,0] op_sel_hi:[0,1,1] neg_lo:[0,1,0]
    s_mov_b32 s4, 0
    v_mov_b32 v56, v72
prep_kernel_la7:
    v_cvt_pk_bf16_f32 v52, v20, -v21
    v_cvt_pk_bf16_f32 v53, v22, -v23
    ds_write_b64 v56, v[52:53] offset:0
    v_cvt_pk_bf16_f32 v54, v32, -v33
    v_cvt_pk_bf16_f32 v55, v34, -v35
    ds_write_b64 v56, v[54:55] offset:8448
    v_pk_mul_f32 v[36:37], v[20:21], v[24:25] op_sel:[0,0] op_sel_hi:[1,0]
    v_pk_mul_f32 v[38:39], v[22:23], v[26:27] op_sel:[0,0] op_sel_hi:[1,0]
    v_pk_fma_f32 v[20:21], v[20:21], v[24:25], v[36:37] op_sel:[1,1,0] op_sel_hi:[0,1,1] neg_lo:[0,1,0]
    v_pk_fma_f32 v[22:23], v[22:23], v[26:27], v[38:39] op_sel:[1,1,0] op_sel_hi:[0,1,1] neg_lo:[0,1,0]
    v_pk_mul_f32 v[40:41], v[32:33], v[24:25] op_sel:[0,0] op_sel_hi:[1,0]
    v_pk_mul_f32 v[42:43], v[34:35], v[26:27] op_sel:[0,0] op_sel_hi:[1,0]
    v_pk_fma_f32 v[32:33], v[32:33], v[24:25], v[40:41] op_sel:[1,1,0] op_sel_hi:[0,1,1] neg_lo:[0,1,0]
    v_pk_fma_f32 v[34:35], v[34:35], v[26:27], v[42:43] op_sel:[1,1,0] op_sel_hi:[0,1,1] neg_lo:[0,1,0]
    v_add_u32 v56, 528, v56
    s_add_u32 s4, s4, 1
    s_cmp_lt_u32 s4, 16
    s_cbranch_scc1 prep_kernel_la7
    s_branch prep_kernel_J5
prep_kernel_B4:
    v_mul_f32 v12, -1.0, v5
    v_mul_f32 v13, 1.0, v2
    v_exp_f32 v12, v12
    v_fract_f32 v13, v13
    v_cos_f32 v14, v13
    v_sin_f32 v15, v13
    v_mul_f32 v16, -1.0, v6
    v_mul_f32 v17, 1.0, v3
    v_exp_f32 v16, v16
    v_fract_f32 v17, v17
    v_cos_f32 v18, v17
    v_sin_f32 v19, v17
    v_mul_f32 v20, v12, v14
    v_mul_f32 v21, v12, v15
    v_mul_f32 v22, v16, v18
    v_mul_f32 v23, v16, v19
    v_mul_f32 v12, -256.0, v5
    v_mul_f32 v13, 256.0, v2
    v_exp_f32 v12, v12
    v_fract_f32 v13, v13
    v_cos_f32 v14, v13
    v_sin_f32 v15, v13
    v_mul_f32 v16, -256.0, v6
    v_mul_f32 v17, 256.0, v3
    v_exp_f32 v16, v16
    v_fract_f32 v17, v17
    v_cos_f32 v18, v17
    v_sin_f32 v19, v17
    v_mul_f32 v24, v12, v14
    v_mul_f32 v25, v12, v15
    v_mul_f32 v26, v16, v18
    v_mul_f32 v27, v16, v19
    v_mov_b32 v12, 0x3f80
    v_mov_b32 v13, 0x3f80
    ds_write_b64 v72, v[12:13] offset:16896
    v_cvt_pk_bf16_f32 v52, v20, v21
    v_cvt_pk_bf16_f32 v53, v22, v23
    ds_write_b64 v72, v[52:53] offset:17424
    v_cvt_pk_bf16_f32 v54, v24, v25
    v_cvt_pk_bf16_f32 v55, v26, v27
    ds_write_b64 v72, v[54:55] offset:21120
    v_pk_mul_f32 v[12:13], v[24:25], v[24:25] op_sel:[0,0] op_sel_hi:[1,0]
    v_pk_mul_f32 v[14:15], v[26:27], v[26:27] op_sel:[0,0] op_sel_hi:[1,0]
    v_pk_fma_f32 v[48:49], v[24:25], v[24:25], v[12:13] op_sel:[1,1,0] op_sel_hi:[0,1,1] neg_lo:[0,1,0]
    v_pk_fma_f32 v[50:51], v[26:27], v[26:27], v[14:15] op_sel:[1,1,0] op_sel_hi:[0,1,1] neg_lo:[0,1,0]
    v_pk_mul_f32 v[44:45], v[20:21], v[20:21] op_sel:[0,0] op_sel_hi:[1,0]
    v_pk_mul_f32 v[46:47], v[22:23], v[22:23] op_sel:[0,0] op_sel_hi:[1,0]
    v_pk_fma_f32 v[28:29], v[20:21], v[20:21], v[44:45] op_sel:[1,1,0] op_sel_hi:[0,1,1] neg_lo:[0,1,0]
    v_pk_fma_f32 v[30:31], v[22:23], v[22:23], v[46:47] op_sel:[1,1,0] op_sel_hi:[0,1,1] neg_lo:[0,1,0]
    v_cvt_pk_bf16_f32 v52, v28, v29
    v_cvt_pk_bf16_f32 v53, v30, v31
    ds_write_b64 v72, v[52:53] offset:17952
    v_pk_mul_f32 v[44:45], v[28:29], v[20:21] op_sel:[0,0] op_sel_hi:[1,0]
    v_pk_mul_f32 v[46:47], v[30:31], v[22:23] op_sel:[0,0] op_sel_hi:[1,0]
    v_pk_fma_f32 v[32:33], v[28:29], v[20:21], v[44:45] op_sel:[1,1,0] op_sel_hi:[0,1,1] neg_lo:[0,1,0]
    v_pk_fma_f32 v[34:35], v[30:31], v[22:23], v[46:47] op_sel:[1,1,0] op_sel_hi:[0,1,1] neg_lo:[0,1,0]
    v_cvt_pk_bf16_f32 v54, v32, v33
    v_cvt_pk_bf16_f32 v55, v34, v35
    ds_write_b64 v72, v[54:55] offset:18480
    v_pk_mul_f32 v[44:45], v[32:33], v[20:21] op_sel:[0,0] op_sel_hi:[1,0]
    v_pk_mul_f32 v[46:47], v[34:35], v[22:23] op_sel:[0,0] op_sel_hi:[1,0]
    v_pk_fma_f32 v[36:37], v[32:33], v[20:21], v[44:45] op_sel:[1,1,0] op_sel_hi:[0,1,1] neg_lo:[0,1,0]
    v_pk_fma_f32 v[38:39], v[34:35], v[22:23], v[46:47] op_sel:[1,1,0] op_sel_hi:[0,1,1] neg_lo:[0,1,0]
    v_cvt_pk_bf16_f32 v52, v36, v37
    v_cvt_pk_bf16_f32 v53, v38, v39
    ds_write_b64 v72, v[52:53] offset:19008
    v_pk_mul_f32 v[44:45], v[36:37], v[20:21] op_sel:[0,0] op_sel_hi:[1,0]
    v_pk_mul_f32 v[46:47], v[38:39], v[22:23] op_sel:[0,0] op_sel_hi:[1,0]
    v_pk_fma_f32 v[32:33], v[36:37], v[20:21], v[44:45] op_sel:[1,1,0] op_sel_hi:[0,1,1] neg_lo:[0,1,0]
    v_pk_fma_f32 v[34:35], v[38:39], v[22:23], v[46:47] op_sel:[1,1,0] op_sel_hi:[0,1,1] neg_lo:[0,1,0]
    v_cvt_pk_bf16_f32 v54, v32, v33
    v_cvt_pk_bf16_f32 v55, v34, v35
    ds_write_b64 v72, v[54:55] offset:19536
    v_pk_mul_f32 v[44:45], v[32:33], v[20:21] op_sel:[0,0] op_sel_hi:[1,0]
    v_pk_mul_f32 v[46:47], v[34:35], v[22:23] op_sel:[0,0] op_sel_hi:[1,0]
    v_pk_fma_f32 v[40:41], v[32:33], v[20:21], v[44:45] op_sel:[1,1,0] op_sel_hi:[0,1,1] neg_lo:[0,1,0]
    v_pk_fma_f32 v[42:43], v[34:35], v[22:23], v[46:47] op_sel:[1,1,0] op_sel_hi:[0,1,1] neg_lo:[0,1,0]
    v_cvt_pk_bf16_f32 v52, v40, v41
    v_cvt_pk_bf16_f32 v53, v42, v43
    ds_write_b64 v72, v[52:53] offset:20064
    v_pk_mul_f32 v[44:45], v[40:41], v[20:21] op_sel:[0,0] op_sel_hi:[1,0]
    v_pk_mul_f32 v[46:47], v[42:43], v[22:23] op_sel:[0,0] op_sel_hi:[1,0]
    v_pk_fma_f32 v[32:33], v[40:41], v[20:21], v[44:45] op_sel:[1,1,0] op_sel_hi:[0,1,1] neg_lo:[0,1,0]
    v_pk_fma_f32 v[34:35], v[42:43], v[22:23], v[46:47] op_sel:[1,1,0] op_sel_hi:[0,1,1] neg_lo:[0,1,0]
    v_cvt_pk_bf16_f32 v54, v32, v33
    v_cvt_pk_bf16_f32 v55, v34, v35
    ds_write_b64 v72, v[54:55] offset:20592
    v_cvt_pk_bf16_f32 v52, v48, v49
    v_cvt_pk_bf16_f32 v53, v50, v51
    ds_write_b64 v72, v[52:53] offset:23232
    v_pk_mul_f32 v[44:45], v[48:49], v[36:37] op_sel:[0,0] op_sel_hi:[1,0]
    v_pk_mul_f32 v[46:47], v[50:51], v[38:39] op_sel:[0,0] op_sel_hi:[1,0]
    v_pk_fma_f32 v[32:33], v[48:49], v[36:37], v[44:45] op_sel:[1,1,0] op_sel_hi:[0,1,1] neg_lo:[0,1,0]
    v_pk_fma_f32 v[34:35], v[50:51], v[38:39], v[46:47] op_sel:[1,1,0] op_sel_hi:[0,1,1] neg_lo:[0,1,0]
    v_cvt_pk_bf16_f32 v54, v32, v33
    v_cvt_pk_bf16_f32 v55, v34, v35
    ds_write_b64 v72, v[54:55] offset:23760
    v_pk_mul_f32 v[12:13], v[48:49], v[24:25] op_sel:[0,0] op_sel_hi:[1,0]
    v_pk_mul_f32 v[14:15], v[50:51], v[26:27] op_sel:[0,0] op_sel_hi:[1,0]
    v_pk_fma_f32 v[48:49], v[48:49], v[24:25], v[12:13] op_sel:[1,1,0] op_sel_hi:[0,1,1] neg_lo:[0,1,0]
    v_pk_fma_f32 v[50:51], v[50:51], v[26:27], v[14:15] op_sel:[1,1,0] op_sel_hi:[0,1,1] neg_lo:[0,1,0]
    v_cvt_pk_bf16_f32 v52, v48, v49
    v_cvt_pk_bf16_f32 v53, v50, v51
    ds_write_b64 v72, v[52:53] offset:24288
    v_pk_mul_f32 v[44:45], v[48:49], v[36:37] op_sel:[0,0] op_sel_hi:[1,0]
    v_pk_mul_f32 v[46:47], v[50:51], v[38:39] op_sel:[0,0] op_sel_hi:[1,0]
    v_pk_fma_f32 v[32:33], v[48:49], v[36:37], v[44:45] op_sel:[1,1,0] op_sel_hi:[0,1,1] neg_lo:[0,1,0]
    v_pk_fma_f32 v[34:35], v[50:51], v[38:39], v[46:47] op_sel:[1,1,0] op_sel_hi:[0,1,1] neg_lo:[0,1,0]
    v_cvt_pk_bf16_f32 v54, v32, v33
    v_cvt_pk_bf16_f32 v55, v34, v35
    ds_write_b64 v72, v[54:55] offset:24816
    v_pk_mul_f32 v[12:13], v[48:49], v[24:25] op_sel:[0,0] op_sel_hi:[1,0]
    v_pk_mul_f32 v[14:15], v[50:51], v[26:27] op_sel:[0,0] op_sel_hi:[1,0]
    v_pk_fma_f32 v[48:49], v[48:49], v[24:25], v[12:13] op_sel:[1,1,0] op_sel_hi:[0,1,1] neg_lo:[0,1,0]
    v_pk_fma_f32 v[50:51], v[50:51], v[26:27], v[14:15] op_sel:[1,1,0] op_sel_hi:[0,1,1] neg_lo:[0,1,0]
    v_pk_mul_f32 v[44:45], v[24:25], v[28:29] op_sel:[0,0] op_sel_hi:[1,0]
    v_pk_mul_f32 v[46:47], v[26:27], v[30:31] op_sel:[0,0] op_sel_hi:[1,0]
    v_pk_fma_f32 v[32:33], v[24:25], v[28:29], v[44:45] op_sel:[1,1,0] op_sel_hi:[0,1,1] neg_lo:[0,1,0]
    v_pk_fma_f32 v[34:35], v[26:27], v[30:31], v[46:47] op_sel:[1,1,0] op_sel_hi:[0,1,1] neg_lo:[0,1,0]
    v_cvt_pk_bf16_f32 v52, v48, v49
    v_cvt_pk_bf16_f32 v53, v50, v51
    ds_write_b64 v72, v[52:53] offset:25344
    v_cvt_pk_bf16_f32 v54, v32, v33
    v_cvt_pk_bf16_f32 v55, v34, v35
    ds_write_b64 v72, v[54:55] offset:21648
    v_pk_mul_f32 v[12:13], v[48:49], v[24:25] op_sel:[0,0] op_sel_hi:[1,0]
    v_pk_mul_f32 v[14:15], v[50:51], v[26:27] op_sel:[0,0] op_sel_hi:[1,0]
    v_pk_fma_f32 v[48:49], v[48:49], v[24:25], v[12:13] op_sel:[1,1,0] op_sel_hi:[0,1,1] neg_lo:[0,1,0]
    v_pk_fma_f32 v[50:51], v[50:51], v[26:27], v[14:15] op_sel:[1,1,0] op_sel_hi:[0,1,1] neg_lo:[0,1,0]
    v_pk_mul_f32 v[44:45], v[24:25], v[36:37] op_sel:[0,0] op_sel_hi:[1,0]
    v_pk_mul_f32 v[46:47], v[26:27], v[38:39] op_sel:[0,0] op_sel_hi:[1,0]
    v_pk_fma_f32 v[32:33], v[24:25], v[36:37], v[44:45] op_sel:[1,1,0] op_sel_hi:[0,1,1] neg_lo:[0,1,0]
    v_pk_fma_f32 v[34:35], v[26:27], v[38:39], v[46:47] op_sel:[1,1,0] op_sel_hi:[0,1,1] neg_lo:[0,1,0]
    v_cvt_pk_bf16_f32 v52, v48, v49
    v_cvt_pk_bf16_f32 v53, v50, v51
    ds_write_b64 v72, v[52:53] offset:25872
    v_cvt_pk_bf16_f32 v54, v32, v33
    v_cvt_pk_bf16_f32 v55, v34, v35
    ds_write_b64 v72, v[54:55] offset:22176
    v_pk_mul_f32 v[12:13], v[48:49], v[24:25] op_sel:[0,0] op_sel_hi:[1,0]
    v_pk_mul_f32 v[14:15], v[50:51], v[26:27] op_sel:[0,0] op_sel_hi:[1,0]
    v_pk_fma_f32 v[48:49], v[48:49], v[24:25], v[12:13] op_sel:[1,1,0] op_sel_hi:[0,1,1] neg_lo:[0,1,0]
    v_pk_fma_f32 v[50:51], v[50:51], v[26:27], v[14:15] op_sel:[1,1,0] op_sel_hi:[0,1,1] neg_lo:[0,1,0]
    v_pk_mul_f32 v[44:45], v[24:25], v[40:41] op_sel:[0,0] op_sel_hi:[1,0]
    v_pk_mul_f32 v[46:47], v[26:27], v[42:43] op_sel:[0,0] op_sel_hi:[1,0]
    v_pk_fma_f32 v[32:33], v[24:25], v[40:41], v[44:45] op_sel:[1,1,0] op_sel_hi:[0,1,1] neg_lo:[0,1,0]
    v_pk_fma_f32 v[34:35], v[26:27], v[42:43], v[46:47] op_sel:[1,1,0] op_sel_hi:[0,1,1] neg_lo:[0,1,0]
    v_cvt_pk_bf16_f32 v52, v48, v49
    v_cvt_pk_bf16_f32 v53, v50, v51
    ds_write_b64 v72, v[52:53] offset:26400
    v_cvt_pk_bf16_f32 v54, v32, v33
    v_cvt_pk_bf16_f32 v55, v34, v35
    ds_write_b64 v72, v[54:55] offset:22704
    v_pk_mul_f32 v[12:13], v[48:49], v[24:25] op_sel:[0,0] op_sel_hi:[1,0]
    v_pk_mul_f32 v[14:15], v[50:51], v[26:27] op_sel:[0,0] op_sel_hi:[1,0]
    v_pk_fma_f32 v[48:49], v[48:49], v[24:25], v[12:13] op_sel:[1,1,0] op_sel_hi:[0,1,1] neg_lo:[0,1,0]
    v_pk_fma_f32 v[50:51], v[50:51], v[26:27], v[14:15] op_sel:[1,1,0] op_sel_hi:[0,1,1] neg_lo:[0,1,0]
    v_cvt_pk_bf16_f32 v52, v48, v49
    v_cvt_pk_bf16_f32 v53, v50, v51
    ds_write_b64 v72, v[52:53] offset:26928
    v_pk_mul_f32 v[12:13], v[48:49], v[24:25] op_sel:[0,0] op_sel_hi:[1,0]
    v_pk_mul_f32 v[14:15], v[50:51], v[26:27] op_sel:[0,0] op_sel_hi:[1,0]
    v_pk_fma_f32 v[48:49], v[48:49], v[24:25], v[12:13] op_sel:[1,1,0] op_sel_hi:[0,1,1] neg_lo:[0,1,0]
    v_pk_fma_f32 v[50:51], v[50:51], v[26:27], v[14:15] op_sel:[1,1,0] op_sel_hi:[0,1,1] neg_lo:[0,1,0]
    v_cvt_pk_bf16_f32 v54, v48, v49
    v_cvt_pk_bf16_f32 v55, v50, v51
    ds_write_b64 v72, v[54:55] offset:27456
prep_kernel_J5:
    s_waitcnt lgkmcnt(0)
    s_barrier
    ds_read_b128 v[100:103], v70 offset:0
    ds_read_b128 v[104:107], v71 offset:16896
    ds_read_b128 v[108:111], v71 offset:25344
    ds_read_b128 v[112:115], v70 offset:64
    ds_read_b128 v[116:119], v71 offset:16960
    ds_read_b128 v[120:123], v71 offset:25408
    ds_read_b128 v[124:127], v70 offset:128
    ds_read_b128 v[128:131], v71 offset:17024
    ds_read_b128 v[132:135], v71 offset:25472
    ds_read_b128 v[136:139], v70 offset:192
    ds_read_b128 v[140:143], v71 offset:17088
    ds_read_b128 v[144:147], v71 offset:25536
    ds_read_b128 v[148:151], v70 offset:256
    ds_read_b128 v[152:155], v71 offset:17152
    ds_read_b128 v[156:159], v71 offset:25600
    s_waitcnt lgkmcnt(6)
    ds_read_b128 v[160:163], v70 offset:320
    ds_read_b128 v[164:167], v71 offset:17216
    ds_read_b128 v[168:171], v71 offset:25664
    ds_read_b128 v[172:175], v70 offset:384
    ds_read_b128 v[176:179], v71 offset:17280
    ds_read_b128 v[180:183], v71 offset:25728
    ds_read_b128 v[184:187], v70 offset:448
    ds_read_b128 v[188:191], v71 offset:17344
    ds_read_b128 v[192:195], v71 offset:25792
    v_mfma_f32_16x16x32_bf16 v[52:55], v[100:103], v[104:107], 0
    v_mfma_f32_16x16x32_bf16 v[56:59], v[100:103], v[108:111], 0
    v_mfma_f32_16x16x32_bf16 v[52:55], v[112:115], v[116:119], v[52:55]
    v_mfma_f32_16x16x32_bf16 v[56:59], v[112:115], v[120:123], v[56:59]
    v_mfma_f32_16x16x32_bf16 v[52:55], v[124:127], v[128:131], v[52:55]
    v_mfma_f32_16x16x32_bf16 v[56:59], v[124:127], v[132:135], v[56:59]
    s_waitcnt lgkmcnt(12)
    v_mfma_f32_16x16x32_bf16 v[52:55], v[136:139], v[140:143], v[52:55]
    v_mfma_f32_16x16x32_bf16 v[56:59], v[136:139], v[144:147], v[56:59]
    s_waitcnt lgkmcnt(9)
    v_mfma_f32_16x16x32_bf16 v[52:55], v[148:151], v[152:155], v[52:55]
    v_mfma_f32_16x16x32_bf16 v[56:59], v[148:151], v[156:159], v[56:59]
    s_waitcnt lgkmcnt(6)
    v_mfma_f32_16x16x32_bf16 v[52:55], v[160:163], v[164:167], v[52:55]
    v_mfma_f32_16x16x32_bf16 v[56:59], v[160:163], v[168:171], v[56:59]
    s_waitcnt lgkmcnt(3)
    v_mfma_f32_16x16x32_bf16 v[52:55], v[172:175], v[176:179], v[52:55]
    v_mfma_f32_16x16x32_bf16 v[56:59], v[172:175], v[180:183], v[56:59]
    s_waitcnt lgkmcnt(0)
    v_mfma_f32_16x16x32_bf16 v[52:55], v[184:187], v[188:191], v[52:55]
    v_mfma_f32_16x16x32_bf16 v[56:59], v[184:187], v[192:195], v[56:59]
    s_nop 6
    v_cvt_pk_bf16_f32 v12, v52, v53
    v_cvt_pk_bf16_f32 v13, v54, v55
    v_cvt_pk_bf16_f32 v14, v56, v57
    v_cvt_pk_bf16_f32 v15, v58, v59
    ds_write_b16 v65, v12
    ds_write_b16_d16_hi v66, v12
    ds_write_b16 v67, v13
    ds_write_b16_d16_hi v68, v13
    ds_write_b16 v69, v14 offset:1024
    ds_write_b16_d16_hi v69, v14 offset:1026
    ds_write_b16 v69, v15 offset:1028
    ds_write_b16_d16_hi v69, v15 offset:1030
    s_mul_i32 s3, s48, 1536
    s_add_u32 s3, s3, 0x100000
    v_lshlrev_b32 v1, 4, v0
    v_add_u32 v2, s64, v1
    v_cmp_gt_u32 vcc, 88, v0
    s_waitcnt lgkmcnt(0)
    s_barrier
    s_and_saveexec_b64 s[4:5], vcc
    ds_read_b128 v[100:103], v2
    s_waitcnt lgkmcnt(0)
    buffer_store_dwordx4 v[100:103], v1, s[8:11], s3 offen
    s_endpgm
prep_kernel_mod1_2:
    s_mov_b32 s8, s46
    s_mov_b32 s9, s47
    s_mov_b32 s10, 0x15c0000
    s_mov_b32 s11, 0x20000
    v_lshlrev_b32 v7, 2, v3
    v_bfe_u32 v1, v4, 4, 2
    v_lshlrev_b32 v5, 5, v2
    v_lshl_add_u32 v5, v1, 3, v5
    s_mul_i32 s6, s4, 12288
    s_lshl_b32 s7, s5, 8
    s_add_u32 s6, s6, s7
    v_mov_b32 v8, 0
    v_mov_b32 v9, 0
    v_mov_b32 v10, 0
    v_mov_b32 v11, 0
    v_mov_b32 v12, 0
    v_mov_b32 v13, 0
    v_mov_b32 v14, 0
    v_mov_b32 v15, 0
    s_waitcnt vmcnt(8)
    v_lshlrev_b32 v6, 16, v6
    v_mul_f32 v1, 0xbfb8aa3b, v6
    v_exp_f32 v1, v1
    s_nop 0
    v_add_f32 v1, 1.0, v1
    v_rcp_f32 v1, v1
    s_nop 0
    v_mul_f32 v1, v6, v1
    v_cvt_pk_bf16_f32 v6, v1, v1
    ds_bpermute_b32 v48, v7, v6 offset:0
    ds_bpermute_b32 v49, v7, v6 offset:32
    ds_bpermute_b32 v50, v7, v6 offset:64
    ds_bpermute_b32 v51, v7, v6 offset:96
    ds_bpermute_b32 v52, v7, v6 offset:128
    ds_bpermute_b32 v53, v7, v6 offset:160
    ds_bpermute_b32 v54, v7, v6 offset:192
    ds_bpermute_b32 v55, v7, v6 offset:224
    s_waitcnt lgkmcnt(0)
    v_and_b32 v56, 0xffff, v48
    v_and_b32 v48, 0xffff0000, v48
    v_and_b32 v57, 0xffff, v49
    v_and_b32 v49, 0xffff0000, v49
    v_and_b32 v58, 0xffff, v50
    v_and_b32 v50, 0xffff0000, v50
    v_and_b32 v59, 0xffff, v51
    v_and_b32 v51, 0xffff0000, v51
    v_and_b32 v60, 0xffff, v52
    v_and_b32 v52, 0xffff0000, v52
    v_and_b32 v61, 0xffff, v53
    v_and_b32 v53, 0xffff0000, v53
    v_and_b32 v62, 0xffff, v54
    v_and_b32 v54, 0xffff0000, v54
    v_and_b32 v63, 0xffff, v55
    v_and_b32 v55, 0xffff0000, v55
    s_waitcnt vmcnt(7)
    v_dot2c_f32_bf16 v8, v16, v56
    v_dot2c_f32_bf16 v9, v16, v48
    v_dot2c_f32_bf16 v10, v17, v56
    v_dot2c_f32_bf16 v11, v17, v48
    v_dot2c_f32_bf16 v12, v18, v56
    v_dot2c_f32_bf16 v13, v18, v48
    v_dot2c_f32_bf16 v14, v19, v56
    v_dot2c_f32_bf16 v15, v19, v48
    s_waitcnt vmcnt(6)
    v_dot2c_f32_bf16 v8, v20, v57
    v_dot2c_f32_bf16 v9, v20, v49
    v_dot2c_f32_bf16 v10, v21, v57
    v_dot2c_f32_bf16 v11, v21, v49
    v_dot2c_f32_bf16 v12, v22, v57
    v_dot2c_f32_bf16 v13, v22, v49
    v_dot2c_f32_bf16 v14, v23, v57
    v_dot2c_f32_bf16 v15, v23, v49
    s_waitcnt vmcnt(5)
    v_dot2c_f32_bf16 v8, v24, v58
    v_dot2c_f32_bf16 v9, v24, v50
    v_dot2c_f32_bf16 v10, v25, v58
    v_dot2c_f32_bf16 v11, v25, v50
    v_dot2c_f32_bf16 v12, v26, v58
    v_dot2c_f32_bf16 v13, v26, v50
    v_dot2c_f32_bf16 v14, v27, v58
    v_dot2c_f32_bf16 v15, v27, v50
    s_waitcnt vmcnt(4)
    v_dot2c_f32_bf16 v8, v28, v59
    v_dot2c_f32_bf16 v9, v28, v51
    v_dot2c_f32_bf16 v10, v29, v59
    v_dot2c_f32_bf16 v11, v29, v51
    v_dot2c_f32_bf16 v12, v30, v59
    v_dot2c_f32_bf16 v13, v30, v51
    v_dot2c_f32_bf16 v14, v31, v59
    v_dot2c_f32_bf16 v15, v31, v51
    s_waitcnt vmcnt(3)
    v_dot2c_f32_bf16 v8, v32, v60
    v_dot2c_f32_bf16 v9, v32, v52
    v_dot2c_f32_bf16 v10, v33, v60
    v_dot2c_f32_bf16 v11, v33, v52
    v_dot2c_f32_bf16 v12, v34, v60
    v_dot2c_f32_bf16 v13, v34, v52
    v_dot2c_f32_bf16 v14, v35, v60
    v_dot2c_f32_bf16 v15, v35, v52
    s_waitcnt vmcnt(2)
    v_dot2c_f32_bf16 v8, v36, v61
    v_dot2c_f32_bf16 v9, v36, v53
    v_dot2c_f32_bf16 v10, v37, v61
    v_dot2c_f32_bf16 v11, v37, v53
    v_dot2c_f32_bf16 v12, v38, v61
    v_dot2c_f32_bf16 v13, v38, v53
    v_dot2c_f32_bf16 v14, v39, v61
    v_dot2c_f32_bf16 v15, v39, v53
    s_waitcnt vmcnt(1)
    v_dot2c_f32_bf16 v8, v40, v62
    v_dot2c_f32_bf16 v9, v40, v54
    v_dot2c_f32_bf16 v10, v41, v62
    v_dot2c_f32_bf16 v11, v41, v54
    v_dot2c_f32_bf16 v12, v42, v62
    v_dot2c_f32_bf16 v13, v42, v54
    v_dot2c_f32_bf16 v14, v43, v62
    v_dot2c_f32_bf16 v15, v43, v54
    s_waitcnt vmcnt(0)
    v_dot2c_f32_bf16 v8, v44, v63
    v_dot2c_f32_bf16 v9, v44, v55
    v_dot2c_f32_bf16 v10, v45, v63
    v_dot2c_f32_bf16 v11, v45, v55
    v_dot2c_f32_bf16 v12, v46, v63
    v_dot2c_f32_bf16 v13, v46, v55
    v_dot2c_f32_bf16 v14, v47, v63
    v_dot2c_f32_bf16 v15, v47, v55
    v_permlane32_swap_b32 v8, v12
    v_permlane32_swap_b32 v9, v13
    v_permlane32_swap_b32 v10, v14
    v_permlane32_swap_b32 v11, v15
    v_add_f32 v8, v8, v12
    v_add_f32 v9, v9, v13
    v_add_f32 v10, v10, v14
    v_add_f32 v11, v11, v15
    s_nop 0
    v_permlane16_swap_b32 v8, v10
    v_permlane16_swap_b32 v9, v11
    v_add_f32 v8, v8, v10
    v_add_f32 v9, v9, v11
    s_nop 0
    v_add_f32_dpp v10, v8, v8 row_ror:8 row_mask:0xf bank_mask:0xf
    v_add_f32_dpp v11, v9, v9 row_ror:8 row_mask:0xf bank_mask:0xf
    buffer_store_dwordx2 v[10:11], v5, s[8:11], s6 offen
    s_cmp_gt_u32 s2, 321
    s_cbranch_scc1 prep_kernel_z9
    v_lshlrev_b32 v1, 4, v0
    v_mov_b32 v12, 0
    v_mov_b32 v13, 0
    v_mov_b32 v14, 0
    v_mov_b32 v15, 0
    s_sub_u32 s6, s2, 256
    s_lshl_b32 s6, s6, 12
    s_add_u32 s6, s6, 0x60000
    s_cmp_ge_u32 s2, 320
    s_cselect_b32 s7, 0xfff7d000, 0
    s_add_u32 s6, s6, s7
    buffer_store_dwordx4 v[12:15], v1, s[8:11], s6 offen
prep_kernel_z9:
    s_endpgm
prep_kernel_st2_2:
    s_mov_b32 s8, s46
    s_mov_b32 s9, s47
    s_mov_b32 s10, 0x15c0000
    s_mov_b32 s11, 0x20000
    v_lshrrev_b32 v5, 2, v0
    v_and_b32 v6, 3, v0
    v_lshrrev_b32 v7, 2, v5
    v_lshlrev_b32 v7, 4, v7
    v_lshl_add_u32 v7, v5, 6, v7
    v_lshl_add_u32 v7, v6, 4, v7
    v_lshlrev_b32 v8, 13, v5
    v_lshl_add_u32 v8, v6, 4, v8
    s_lshl_b32 s4, s3, 2
    s_add_u32 s4, s4, 0x13c0000
    v_lshlrev_b32 v1, 3, v1
    s_mov_b32 s6, 0x18000
    v_mov_b32 v5, 0
    v_mov_b32 v6, 0
    s_waitcnt vmcnt(3)
    ds_write_b32 v14, v16 offset:0
    v_dot2c_f32_bf16 v5, s60, v16
    ds_write_b32 v14, v17 offset:64
    v_dot2c_f32_bf16 v6, s60, v17
    ds_write_b32 v14, v18 offset:128
    v_dot2c_f32_bf16 v5, s60, v18
    ds_write_b32 v14, v19 offset:192
    v_dot2c_f32_bf16 v6, s60, v19
    s_waitcnt vmcnt(2)
    ds_write_b32 v14, v20 offset:4352
    v_dot2c_f32_bf16 v5, s60, v20
    ds_write_b32 v14, v21 offset:4416
    v_dot2c_f32_bf16 v6, s60, v21
    ds_write_b32 v14, v22 offset:4480
    v_dot2c_f32_bf16 v5, s60, v22
    ds_write_b32 v14, v23 offset:4544
    v_dot2c_f32_bf16 v6, s60, v23
    s_waitcnt vmcnt(1)
    ds_write_b32 v14, v24 offset:8704
    v_dot2c_f32_bf16 v5, s60, v24
    ds_write_b32 v14, v25 offset:8768
    v_dot2c_f32_bf16 v6, s60, v25
    ds_write_b32 v14, v26 offset:8832
    v_dot2c_f32_bf16 v5, s60, v26
    ds_write_b32 v14, v27 offset:8896
    v_dot2c_f32_bf16 v6, s60, v27
    s_waitcnt vmcnt(0)
    ds_write_b32 v14, v28 offset:13056
    v_dot2c_f32_bf16 v5, s60, v28
    ds_write_b32 v14, v29 offset:13120
    v_dot2c_f32_bf16 v6, s60, v29
    ds_write_b32 v14, v30 offset:13184
    v_dot2c_f32_bf16 v5, s60, v30
    ds_write_b32 v14, v31 offset:13248
    v_dot2c_f32_bf16 v6, s60, v31
    s_nop 2
    v_add_f32 v5, v5, v6
    s_waitcnt lgkmcnt(0)
    s_barrier
    ds_read_b128 v[32:35], v7 offset:0
    ds_read_b128 v[36:39], v7 offset:4352
    ds_read_b128 v[40:43], v7 offset:8704
    ds_read_b128 v[44:47], v7 offset:13056
    v_add_f32_dpp v5, v5, v5 row_ror:8 row_mask:0xf bank_mask:0xf
    s_nop 1
    v_add_f32_dpp v5, v5, v5 row_ror:4 row_mask:0xf bank_mask:0xf
    s_nop 1
    v_add_f32_dpp v5, v5, v5 row_ror:2 row_mask:0xf bank_mask:0xf
    s_nop 1
    v_add_f32_dpp v5, v5, v5 row_ror:1 row_mask:0xf bank_mask:0xf
    v_mul_f32 v5, 0.001953125, v5
    v_mov_b32 v6, 0
    v_mov_b32 v9, 0
    s_waitcnt lgkmcnt(3)
    buffer_store_dwordx4 v[32:35], v8, s[8:11], s4 offen
    s_add_u32 s4, s4, 524288
    s_waitcnt lgkmcnt(2)
    buffer_store_dwordx4 v[36:39], v8, s[8:11], s4 offen
    s_add_u32 s4, s4, 524288
    s_waitcnt lgkmcnt(1)
    buffer_store_dwordx4 v[40:43], v8, s[8:11], s4 offen
    s_add_u32 s4, s4, 524288
    s_waitcnt lgkmcnt(0)
    buffer_store_dwordx4 v[44:47], v8, s[8:11], s4 offen
    v_lshlrev_b32 v48, 16, v16
    v_and_b32 v49, 0xffff0000, v16
    v_sub_f32 v48, v48, v5
    v_sub_f32 v49, v49, v5
    v_fmac_f32 v6, v48, v48
    v_fmac_f32 v9, v49, v49
    v_lshlrev_b32 v50, 16, v17
    v_and_b32 v51, 0xffff0000, v17
    v_sub_f32 v50, v50, v5
    v_sub_f32 v51, v51, v5
    v_fmac_f32 v6, v50, v50
    v_fmac_f32 v9, v51, v51
    v_lshlrev_b32 v48, 16, v18
    v_and_b32 v49, 0xffff0000, v18
    v_sub_f32 v48, v48, v5
    v_sub_f32 v49, v49, v5
    v_fmac_f32 v6, v48, v48
    v_fmac_f32 v9, v49, v49
    v_lshlrev_b32 v50, 16, v19
    v_and_b32 v51, 0xffff0000, v19
    v_sub_f32 v50, v50, v5
    v_sub_f32 v51, v51, v5
    v_fmac_f32 v6, v50, v50
    v_fmac_f32 v9, v51, v51
    v_lshlrev_b32 v48, 16, v20
    v_and_b32 v49, 0xffff0000, v20
    v_sub_f32 v48, v48, v5
    v_sub_f32 v49, v49, v5
    v_fmac_f32 v6, v48, v48
    v_fmac_f32 v9, v49, v49
    v_lshlrev_b32 v50, 16, v21
    v_and_b32 v51, 0xffff0000, v21
    v_sub_f32 v50, v50, v5
    v_sub_f32 v51, v51, v5
    v_fmac_f32 v6, v50, v50
    v_fmac_f32 v9, v51, v51
    v_lshlrev_b32 v48, 16, v22
    v_and_b32 v49, 0xffff0000, v22
    v_sub_f32 v48, v48, v5
    v_sub_f32 v49, v49, v5
    v_fmac_f32 v6, v48, v48
    v_fmac_f32 v9, v49, v49
    v_lshlrev_b32 v50, 16, v23
    v_and_b32 v51, 0xffff0000, v23
    v_sub_f32 v50, v50, v5
    v_sub_f32 v51, v51, v5
    v_fmac_f32 v6, v50, v50
    v_fmac_f32 v9, v51, v51
    v_lshlrev_b32 v48, 16, v24
    v_and_b32 v49, 0xffff0000, v24
    v_sub_f32 v48, v48, v5
    v_sub_f32 v49, v49, v5
    v_fmac_f32 v6, v48, v48
    v_fmac_f32 v9, v49, v49
    v_lshlrev_b32 v50, 16, v25
    v_and_b32 v51, 0xffff0000, v25
    v_sub_f32 v50, v50, v5
    v_sub_f32 v51, v51, v5
    v_fmac_f32 v6, v50, v50
    v_fmac_f32 v9, v51, v51
    v_lshlrev_b32 v48, 16, v26
    v_and_b32 v49, 0xffff0000, v26
    v_sub_f32 v48, v48, v5
    v_sub_f32 v49, v49, v5
    v_fmac_f32 v6, v48, v48
    v_fmac_f32 v9, v49, v49
    v_lshlrev_b32 v50, 16, v27
    v_and_b32 v51, 0xffff0000, v27
    v_sub_f32 v50, v50, v5
    v_sub_f32 v51, v51, v5
    v_fmac_f32 v6, v50, v50
    v_fmac_f32 v9, v51, v51
    v_lshlrev_b32 v48, 16, v28
    v_and_b32 v49, 0xffff0000, v28
    v_sub_f32 v48, v48, v5
    v_sub_f32 v49, v49, v5
    v_fmac_f32 v6, v48, v48
    v_fmac_f32 v9, v49, v49
    v_lshlrev_b32 v50, 16, v29
    v_and_b32 v51, 0xffff0000, v29
    v_sub_f32 v50, v50, v5
    v_sub_f32 v51, v51, v5
    v_fmac_f32 v6, v50, v50
    v_fmac_f32 v9, v51, v51
    v_lshlrev_b32 v48, 16, v30
    v_and_b32 v49, 0xffff0000, v30
    v_sub_f32 v48, v48, v5
    v_sub_f32 v49, v49, v5
    v_fmac_f32 v6, v48, v48
    v_fmac_f32 v9, v49, v49
    v_lshlrev_b32 v50, 16, v31
    v_and_b32 v51, 0xffff0000, v31
    v_sub_f32 v50, v50, v5
    v_sub_f32 v51, v51, v5
    v_fmac_f32 v6, v50, v50
    v_fmac_f32 v9, v51, v51
    v_add_f32 v6, v6, v9
    s_nop 1
    v_add_f32_dpp v6, v6, v6 row_ror:8 row_mask:0xf bank_mask:0xf
    s_nop 1
    v_add_f32_dpp v6, v6, v6 row_ror:4 row_mask:0xf bank_mask:0xf
    s_nop 1
    v_add_f32_dpp v6, v6, v6 row_ror:2 row_mask:0xf bank_mask:0xf
    s_nop 1
    v_add_f32_dpp v6, v6, v6 row_ror:1 row_mask:0xf bank_mask:0xf
    v_mul_f32 v6, 0.001953125, v6
    v_cvt_pk_bf16_f32 v6, v6, v6
    v_and_b32 v6, 0xffff0000, v6
    v_add_f32 v6, 0x3727c5ac, v6
    v_cvt_pk_bf16_f32 v6, v6, v6
    v_and_b32 v6, 0xffff0000, v6
    v_sqrt_f32 v6, v6
    s_nop 0
    v_cvt_pk_bf16_f32 v6, v6, v6
    v_and_b32 v6, 0xffff0000, v6
    v_rcp_f32 v11, v6
    v_cvt_pk_bf16_f32 v10, v5, v5
    v_and_b32 v10, 0xffff0000, v10
    v_cmp_eq_u32 vcc, 0, v2
    s_nop 0
    s_and_saveexec_b64 s[4:5], vcc
    buffer_store_dwordx2 v[10:11], v1, s[8:11], s6 offen
prep_kernel_end3:
    s_endpgm
.globl conv_kernel
.p2align 8
.type conv_kernel,@function
conv_kernel:
    s_getpc_b64 s[88:89]
    s_load_dwordx16 s[16:31], s[0:1], 0
    s_load_dwordx16 s[32:47], s[0:1], 64
    s_lshr_b32 s87, s2, 3
    s_and_b32 s87, s87, 1
    s_lshl_b32 s87, s87, 13
    v_lshl_add_u32 v234, v0, 4, s87
    v_min_u32 v234, code_end-conv_kernel-32, v234
    global_load_dwordx4 v[236:239], v234, s[88:89]
    s_cmp_ge_u32 s2, 256
    s_cbranch_scc1 conv_kernel_end1
    s_and_b32 s3, s2, 7
    s_lshr_b32 s4, s2, 3
    s_lshl_b32 s48, s3, 6
    s_lshl_b32 s4, s4, 1
    s_add_u32 s48, s48, s4
    v_and_b32 v4, 63, v0
    v_lshrrev_b32 v5, 6, v0
    s_nop 0
    v_readfirstlane_b32 s50, v5
    v_lshlrev_b32 v9, 4, v4
    v_lshlrev_b32 v1, 5, v0
    v_lshlrev_b32 v2, 6, v0
    s_lshl_b32 s59, s48, 12
    s_add_u32 s59, s59, 0x13c0000
    s_mov_b32 s55, 0x18000
    s_lshl_b32 s51, s48, 1
    v_lshrrev_b32 v6, 4, v4
    v_add_u32 v7, 1, v6
    v_lshrrev_b32 v7, 2, v7
    v_lshl_add_u32 v6, v7, 1, v6
    v_lshlrev_b32 v6, 11, v6
    v_and_b32 v7, 7, v4
    v_mul_u32_u24 v7, 12288, v7
    v_bfe_u32 v8, v4, 3, 1
    v_add_u32 v8, s48, v8
    v_lshl_add_u32 v6, v8, 2, v6
    v_add_u32 v6, v6, v7
    s_waitcnt lgkmcnt(0)
    s_mov_b32 s8, s46
    s_mov_b32 s9, s47
    s_mov_b32 s10, 0x15c0000
    s_mov_b32 s11, 0x20000
    v_mov_b32 v230, 118656
    v_cmp_eq_u32 vcc, 0, v4
    s_nop 1
    v_cndmask_b32 v231, 0, 1, vcc
    s_cmp_lt_u32 s50, 4
    s_cbranch_scc1 conv_kernel_J3
conv_kernel_P2:
    v_and_b32 v140, 127, v0
    s_sub_u32 s56, s50, 4
    s_lshr_b32 s56, s56, 1
    s_add_u32 s4, s48, s56
    s_mul_i32 s4, s4, 1536
    s_add_u32 s4, s4, 0x100000
    v_add_u32 v141, 64, v4
    v_min_u32 v141, 87, v141
    v_lshlrev_b32 v141, 4, v141
    buffer_load_dwordx4 v[144:147], v9, s[8:11], s4 offen
    buffer_load_dwordx4 v[196:199], v141, s[8:11], s4 offen
    s_sub_u32 s64, s50, 4
    s_mul_i32 s64, s64, 1552
    s_add_u32 s64, s64, 118736
    s_and_b32 s52, s2, 7
    s_lshr_b32 s53, s2, 3
    s_min_u32 s53, s53, 27
    s_mov_b32 s90, s52
    s_mov_b32 s91, s53
    v_subrev_u32 v100, 256, v0
    v_lshrrev_b32 v101, 3, v100
    v_and_b32 v102, 7, v100
    s_lshl_b32 s54, s52, 6
    v_add_u32 v103, s54, v101
    v_mul_u32_u24 v110, 12288, v102
    v_lshl_add_u32 v110, v103, 2, v110
    v_add_u32 v110, 6144, v110
    v_mul_u32_u24 v106, 3584, v103
    v_lshl_add_u32 v106, v102, 4, v106
    s_lshl_b32 s54, s53, 7
    v_add_u32 v106, s54, v106
    v_add_u32 v107, 114688, v106
    s_lshl_b32 s54, s91, 16
    s_lshl_b32 s55, s90, 7
    s_add_u32 s54, s54, s55
    v_lshlrev_b32 v108, 10, v101
    v_lshl_add_u32 v108, v102, 4, v108
    v_add_u32 v108, s54, v108
    v_add_u32 v109, 32768, v108
    buffer_load_dword v112, v110, s[8:11], 0 offen
    buffer_load_dword v113, v110, s[8:11], 0 offen offset:128
    buffer_load_dword v114, v110, s[8:11], 0 offen offset:2048
    buffer_load_dword v115, v110, s[8:11], 0 offen offset:2176
    global_load_dwordx4 v[116:119], v106, s[32:33]
    global_load_dwordx4 v[120:123], v107, s[32:33]
    global_load_dwordx4 v[124:127], v106, s[34:35]
    global_load_dwordx4 v[128:131], v107, s[34:35]
    global_load_dwordx4 v[132:135], v108, s[36:37]
    global_load_dwordx4 v[136:139], v109, s[36:37]
    s_branch conv_kernel_P2_2
conv_kernel_J3:
    buffer_load_dword v40, v6, s[8:11], 0 offen
    buffer_load_dwordx4 v[16:19], v1, s[8:11], s59 offen
    buffer_load_dwordx4 v[20:23], v1, s[8:11], s59 offen offset:16
    buffer_load_dwordx4 v[24:27], v2, s[8:11], s55 offen offset:0
    buffer_load_dwordx4 v[28:31], v2, s[8:11], s55 offen offset:16
    buffer_load_dwordx4 v[32:35], v2, s[8:11], s55 offen offset:32
    buffer_load_dwordx4 v[36:39], v2, s[8:11], s55 offen offset:48
    s_load_dword s49, s[28:29], s51
    v_and_b32 v10, 15, v4
    v_lshrrev_b32 v11, 4, v4
    s_lshr_b32 s56, s50, 1
    s_and_b32 s57, s50, 1
    s_lshl_b32 s57, s57, 8
    v_lshlrev_b32 v12, 3, v11
    v_sub_u32 v12, v12, v10
    v_add_u32 v12, 2031, v12
    v_and_b32 v12, 0xfffffffe, v12
    v_lshlrev_b32 v12, 1, v12
    v_and_b32 v13, 1, v10
    v_xor_b32 v13, 1, v13
    v_mul_u32_u24 v13, 4160, v13
    v_add_u32 v12, v12, v13
    s_mul_i32 s58, s56, 8320
    s_sub_u32 s58, s58, s57
    s_add_u32 s58, s58, -3648
    v_add_u32 v224, s58, v12
    v_add_u32 v225, 1024, v224
    v_add_u32 v226, 2048, v224
    v_add_u32 v227, 3072, v224
    v_lshlrev_b32 v13, 5, v10
    v_lshl_add_u32 v13, v11, 4, v13
    s_mul_i32 s58, s56, 4608
    s_sub_u32 s58, s58, s57
    s_add_u32 s58, s58, 17056
    v_add_u32 v13, s58, v13
    v_mov_b32 v64, 0
    v_mov_b32 v65, 0
    v_mov_b32 v66, 0
    v_mov_b32 v67, 0
    v_mov_b32 v68, 0
    v_mov_b32 v69, 0
    v_mov_b32 v70, 0
    v_mov_b32 v71, 0
    v_mov_b32 v72, 0
    v_mov_b32 v73, 0
    v_mov_b32 v74, 0
    v_mov_b32 v75, 0
    v_mov_b32 v76, 0
    v_mov_b32 v77, 0
    v_mov_b32 v78, 0
    v_mov_b32 v79, 0
    v_mov_b32 v80, 0
    v_mov_b32 v81, 0
    v_mov_b32 v82, 0
    v_mov_b32 v83, 0
    v_mov_b32 v84, 0
    v_mov_b32 v85, 0
    v_mov_b32 v86, 0
    v_mov_b32 v87, 0
    v_mov_b32 v88, 0
    v_mov_b32 v89, 0
    v_mov_b32 v90, 0
    v_mov_b32 v91, 0
    v_mov_b32 v92, 0
    v_mov_b32 v93, 0
    v_mov_b32 v94, 0
    v_mov_b32 v95, 0
    s_waitcnt vmcnt(6)
    v_add_f32_dpp v40, v40, v40 quad_perm:[1,0,3,2] row_mask:0xf bank_mask:0xf
    s_nop 1
    v_add_f32_dpp v40, v40, v40 quad_perm:[2,3,0,1] row_mask:0xf bank_mask:0xf
    s_nop 1
    v_add_f32_dpp v40, v40, v40 row_half_mirror row_mask:0xf bank_mask:0xf
    v_cvt_pk_bf16_f32 v40, v40, v40
    v_and_b32 v40, 0xffff0000, v40
    v_add_f32 v41, 1.0, v40
    v_cvt_pk_bf16_f32 v41, v41, v41
    v_and_b32 v41, 0xffff0000, v41
    v_readlane_b32 s60, v40, 0
    v_readlane_b32 s61, v40, 8
    v_readlane_b32 s62, v41, 16
    v_readlane_b32 s63, v41, 24
    v_readlane_b32 s64, v40, 32
    v_readlane_b32 s65, v40, 40
    v_readlane_b32 s66, v40, 48
    v_readlane_b32 s67, v40, 56
    v_lshlrev_b32 v5, 4, v0
    s_waitcnt lgkmcnt(0)
    s_lshl_b32 s68, s49, 16
    s_and_b32 s69, s49, 0xffff0000
    s_waitcnt vmcnt(0)
    ds_write_b128 v1, v[16:19] offset:25856
    ds_write_b128 v1, v[20:23] offset:25872
    v_lshlrev_b32 v48, 16, v16
    v_and_b32 v49, 0xffff0000, v16
    v_pk_add_f32 v[48:49], v[48:49], v[24:25] op_sel:[0,0] op_sel_hi:[1,0] neg_lo:[0,1] neg_hi:[0,1]
    v_lshlrev_b32 v50, 16, v17
    v_and_b32 v51, 0xffff0000, v17
    v_pk_add_f32 v[50:51], v[50:51], v[26:27] op_sel:[0,0] op_sel_hi:[1,0] neg_lo:[0,1] neg_hi:[0,1]
    v_lshlrev_b32 v52, 16, v18
    v_and_b32 v53, 0xffff0000, v18
    v_pk_add_f32 v[52:53], v[52:53], v[28:29] op_sel:[0,0] op_sel_hi:[1,0] neg_lo:[0,1] neg_hi:[0,1]
    v_lshlrev_b32 v54, 16, v19
    v_and_b32 v55, 0xffff0000, v19
    v_pk_add_f32 v[54:55], v[54:55], v[30:31] op_sel:[0,0] op_sel_hi:[1,0] neg_lo:[0,1] neg_hi:[0,1]
    v_lshlrev_b32 v56, 16, v20
    v_and_b32 v57, 0xffff0000, v20
    v_pk_add_f32 v[56:57], v[56:57], v[32:33] op_sel:[0,0] op_sel_hi:[1,0] neg_lo:[0,1] neg_hi:[0,1]
    v_lshlrev_b32 v58, 16, v21
    v_and_b32 v59, 0xffff0000, v21
    v_pk_add_f32 v[58:59], v[58:59], v[34:35] op_sel:[0,0] op_sel_hi:[1,0] neg_lo:[0,1] neg_hi:[0,1]
    v_lshlrev_b32 v60, 16, v22
    v_and_b32 v61, 0xffff0000, v22
    v_pk_add_f32 v[60:61], v[60:61], v[36:37] op_sel:[0,0] op_sel_hi:[1,0] neg_lo:[0,1] neg_hi:[0,1]
    v_lshlrev_b32 v62, 16, v23
    v_and_b32 v63, 0xffff0000, v23
    v_pk_add_f32 v[62:63], v[62:63], v[38:39] op_sel:[0,0] op_sel_hi:[1,0] neg_lo:[0,1] neg_hi:[0,1]
    v_cvt_pk_bf16_f32 v42, v48, v49
    v_lshlrev_b32 v48, 16, v42
    v_and_b32 v49, 0xffff0000, v42
    v_pk_mul_f32 v[48:49], v[48:49], v[24:25] op_sel:[0,1] op_sel_hi:[1,1]
    v_cvt_pk_bf16_f32 v43, v50, v51
    v_lshlrev_b32 v50, 16, v43
    v_and_b32 v51, 0xffff0000, v43
    v_pk_mul_f32 v[50:51], v[50:51], v[26:27] op_sel:[0,1] op_sel_hi:[1,1]
    v_cvt_pk_bf16_f32 v42, v52, v53
    v_lshlrev_b32 v52, 16, v42
    v_and_b32 v53, 0xffff0000, v42
    v_pk_mul_f32 v[52:53], v[52:53], v[28:29] op_sel:[0,1] op_sel_hi:[1,1]
    v_cvt_pk_bf16_f32 v43, v54, v55
    v_lshlrev_b32 v54, 16, v43
    v_and_b32 v55, 0xffff0000, v43
    v_pk_mul_f32 v[54:55], v[54:55], v[30:31] op_sel:[0,1] op_sel_hi:[1,1]
    v_cvt_pk_bf16_f32 v42, v56, v57
    v_lshlrev_b32 v56, 16, v42
    v_and_b32 v57, 0xffff0000, v42
    v_pk_mul_f32 v[56:57], v[56:57], v[32:33] op_sel:[0,1] op_sel_hi:[1,1]
    v_cvt_pk_bf16_f32 v43, v58, v59
    v_lshlrev_b32 v58, 16, v43
    v_and_b32 v59, 0xffff0000, v43
    v_pk_mul_f32 v[58:59], v[58:59], v[34:35] op_sel:[0,1] op_sel_hi:[1,1]
    v_cvt_pk_bf16_f32 v42, v60, v61
    v_lshlrev_b32 v60, 16, v42
    v_and_b32 v61, 0xffff0000, v42
    v_pk_mul_f32 v[60:61], v[60:61], v[36:37] op_sel:[0,1] op_sel_hi:[1,1]
    v_cvt_pk_bf16_f32 v43, v62, v63
    v_lshlrev_b32 v62, 16, v43
    v_and_b32 v63, 0xffff0000, v43
    v_pk_mul_f32 v[62:63], v[62:63], v[38:39] op_sel:[0,1] op_sel_hi:[1,1]
    v_cvt_pk_bf16_f32 v42, v48, v49
    v_lshlrev_b32 v48, 16, v42
    v_and_b32 v49, 0xffff0000, v42
    v_pk_mul_f32 v[48:49], v[48:49], s[62:63]
    v_cvt_pk_bf16_f32 v43, v50, v51
    v_lshlrev_b32 v50, 16, v43
    v_and_b32 v51, 0xffff0000, v43
    v_pk_mul_f32 v[50:51], v[50:51], s[62:63]
    v_cvt_pk_bf16_f32 v42, v52, v53
    v_lshlrev_b32 v52, 16, v42
    v_and_b32 v53, 0xffff0000, v42
    v_pk_mul_f32 v[52:53], v[52:53], s[62:63]
    v_cvt_pk_bf16_f32 v43, v54, v55
    v_lshlrev_b32 v54, 16, v43
    v_and_b32 v55, 0xffff0000, v43
    v_pk_mul_f32 v[54:55], v[54:55], s[62:63]
    v_cvt_pk_bf16_f32 v42, v56, v57
    v_lshlrev_b32 v56, 16, v42
    v_and_b32 v57, 0xffff0000, v42
    v_pk_mul_f32 v[56:57], v[56:57], s[62:63]
    v_cvt_pk_bf16_f32 v43, v58, v59
    v_lshlrev_b32 v58, 16, v43
    v_and_b32 v59, 0xffff0000, v43
    v_pk_mul_f32 v[58:59], v[58:59], s[62:63]
    v_cvt_pk_bf16_f32 v42, v60, v61
    v_lshlrev_b32 v60, 16, v42
    v_and_b32 v61, 0xffff0000, v42
    v_pk_mul_f32 v[60:61], v[60:61], s[62:63]
    v_cvt_pk_bf16_f32 v43, v62, v63
    v_lshlrev_b32 v62, 16, v43
    v_and_b32 v63, 0xffff0000, v43
    v_pk_mul_f32 v[62:63], v[62:63], s[62:63]
    v_cvt_pk_bf16_f32 v42, v48, v49
    v_lshlrev_b32 v48, 16, v42
    v_and_b32 v49, 0xffff0000, v42
    v_pk_add_f32 v[48:49], v[48:49], s[60:61]
    v_cvt_pk_bf16_f32 v43, v50, v51
    v_lshlrev_b32 v50, 16, v43
    v_and_b32 v51, 0xffff0000, v43
    v_pk_add_f32 v[50:51], v[50:51], s[60:61]
    v_cvt_pk_bf16_f32 v42, v52, v53
    v_lshlrev_b32 v52, 16, v42
    v_and_b32 v53, 0xffff0000, v42
    v_pk_add_f32 v[52:53], v[52:53], s[60:61]
    v_cvt_pk_bf16_f32 v43, v54, v55
    v_lshlrev_b32 v54, 16, v43
    v_and_b32 v55, 0xffff0000, v43
    v_pk_add_f32 v[54:55], v[54:55], s[60:61]
    v_cvt_pk_bf16_f32 v42, v56, v57
    v_lshlrev_b32 v56, 16, v42
    v_and_b32 v57, 0xffff0000, v42
    v_pk_add_f32 v[56:57], v[56:57], s[60:61]
    v_cvt_pk_bf16_f32 v43, v58, v59
    v_lshlrev_b32 v58, 16, v43
    v_and_b32 v59, 0xffff0000, v43
    v_pk_add_f32 v[58:59], v[58:59], s[60:61]
    v_cvt_pk_bf16_f32 v42, v60, v61
    v_lshlrev_b32 v60, 16, v42
    v_and_b32 v61, 0xffff0000, v42
    v_pk_add_f32 v[60:61], v[60:61], s[60:61]
    v_cvt_pk_bf16_f32 v43, v62, v63
    v_lshlrev_b32 v62, 16, v43
    v_and_b32 v63, 0xffff0000, v43
    v_pk_add_f32 v[62:63], v[62:63], s[60:61]
    v_cvt_pk_bf16_f32 v24, v48, v50
    v_cvt_pk_bf16_f32 v28, v49, v51
    v_cvt_pk_bf16_f32 v25, v52, v54
    v_cvt_pk_bf16_f32 v29, v53, v55
    v_cvt_pk_bf16_f32 v26, v56, v58
    v_cvt_pk_bf16_f32 v30, v57, v59
    v_cvt_pk_bf16_f32 v27, v60, v62
    v_cvt_pk_bf16_f32 v31, v61, v63
    ds_write_b128 v5, v[24:27] offset:17152
    ds_write_b128 v5, v[28:31] offset:21760
    s_waitcnt vmcnt(0) lgkmcnt(0)
    s_barrier
    s_setprio 2
    ds_read2_b32 v[96:97], v227 offset0:144 offset1:145
    ds_read2_b32 v[98:99], v227 offset0:146 offset1:147
    ds_read_b128 v[128:131], v13 offset:64
    ds_read2_b32 v[100:101], v227 offset0:16 offset1:17
    ds_read2_b32 v[102:103], v227 offset0:18 offset1:19
    ds_read_b128 v[132:135], v13 offset:576
    ds_read2_b32 v[104:105], v226 offset0:144 offset1:145
    ds_read2_b32 v[106:107], v226 offset0:146 offset1:147
    ds_read_b128 v[136:139], v13 offset:1088
    ds_read2_b32 v[108:109], v226 offset0:16 offset1:17
    ds_read2_b32 v[110:111], v226 offset0:18 offset1:19
    ds_read_b128 v[140:143], v13 offset:1600
    ds_read2_b32 v[112:113], v225 offset0:144 offset1:145
    ds_read2_b32 v[114:115], v225 offset0:146 offset1:147
    ds_read_b128 v[144:147], v13 offset:2112
    ds_read2_b32 v[116:117], v225 offset0:16 offset1:17
    ds_read2_b32 v[118:119], v225 offset0:18 offset1:19
    ds_read_b128 v[148:151], v13 offset:2624
    ds_read2_b32 v[120:121], v224 offset0:144 offset1:145
    ds_read2_b32 v[122:123], v224 offset0:146 offset1:147
    ds_read_b128 v[152:155], v13 offset:3136
    ds_read2_b32 v[124:125], v224 offset0:16 offset1:17
    ds_read2_b32 v[126:127], v224 offset0:18 offset1:19
    ds_read_b128 v[156:159], v13 offset:3648
    s_mov_b32 s4, 0
conv_kernel_cl5:
    s_waitcnt lgkmcnt(0)
    v_mfma_f32_16x16x32_bf16 v[64:67], v[96:99], v[128:131], v[64:67]
    ds_read2_b32 v[160:161], v227 offset0:128 offset1:129
    v_mfma_f32_16x16x32_bf16 v[68:71], v[96:99], v[132:135], v[68:71]
    ds_read2_b32 v[162:163], v227 offset0:130 offset1:131
    v_mfma_f32_16x16x32_bf16 v[68:71], v[100:103], v[128:131], v[68:71]
    v_mfma_f32_16x16x32_bf16 v[72:75], v[100:103], v[132:135], v[72:75]
    ds_read_b128 v[192:195], v13 offset:0
    v_mfma_f32_16x16x32_bf16 v[72:75], v[96:99], v[136:139], v[72:75]
    ds_read2_b32 v[164:165], v227 offset0:0 offset1:1
    v_mfma_f32_16x16x32_bf16 v[76:79], v[100:103], v[136:139], v[76:79]
    v_mfma_f32_16x16x32_bf16 v[72:75], v[104:107], v[128:131], v[72:75]
    ds_read2_b32 v[166:167], v227 offset0:2 offset1:3
    v_mfma_f32_16x16x32_bf16 v[76:79], v[104:107], v[132:135], v[76:79]
    ds_read_b128 v[196:199], v13 offset:512
    v_mfma_f32_16x16x32_bf16 v[80:83], v[104:107], v[136:139], v[80:83]
    v_mfma_f32_16x16x32_bf16 v[76:79], v[96:99], v[140:143], v[76:79]
    ds_read2_b32 v[168:169], v226 offset0:128 offset1:129
    v_mfma_f32_16x16x32_bf16 v[80:83], v[100:103], v[140:143], v[80:83]
    ds_read2_b32 v[170:171], v226 offset0:130 offset1:131
    v_mfma_f32_16x16x32_bf16 v[84:87], v[104:107], v[140:143], v[84:87]
    v_mfma_f32_16x16x32_bf16 v[76:79], v[108:111], v[128:131], v[76:79]
    ds_read_b128 v[200:203], v13 offset:1024
    v_mfma_f32_16x16x32_bf16 v[80:83], v[108:111], v[132:135], v[80:83]
    ds_read2_b32 v[172:173], v226 offset0:0 offset1:1
    v_mfma_f32_16x16x32_bf16 v[84:87], v[108:111], v[136:139], v[84:87]
    v_mfma_f32_16x16x32_bf16 v[88:91], v[108:111], v[140:143], v[88:91]
    ds_read2_b32 v[174:175], v226 offset0:2 offset1:3
    v_mfma_f32_16x16x32_bf16 v[80:83], v[96:99], v[144:147], v[80:83]
    ds_read_b128 v[204:207], v13 offset:1536
    v_mfma_f32_16x16x32_bf16 v[84:87], v[100:103], v[144:147], v[84:87]
    v_mfma_f32_16x16x32_bf16 v[88:91], v[104:107], v[144:147], v[88:91]
    ds_read2_b32 v[176:177], v225 offset0:128 offset1:129
    v_mfma_f32_16x16x32_bf16 v[92:95], v[108:111], v[144:147], v[92:95]
    ds_read2_b32 v[178:179], v225 offset0:130 offset1:131
    v_mfma_f32_16x16x32_bf16 v[80:83], v[112:115], v[128:131], v[80:83]
    v_mfma_f32_16x16x32_bf16 v[84:87], v[112:115], v[132:135], v[84:87]
    ds_read_b128 v[208:211], v13 offset:2048
    v_mfma_f32_16x16x32_bf16 v[88:91], v[112:115], v[136:139], v[88:91]
    ds_read2_b32 v[180:181], v225 offset0:0 offset1:1
    v_mfma_f32_16x16x32_bf16 v[92:95], v[112:115], v[140:143], v[92:95]
    v_mfma_f32_16x16x32_bf16 v[84:87], v[96:99], v[148:151], v[84:87]
    ds_read2_b32 v[182:183], v225 offset0:2 offset1:3
    v_mfma_f32_16x16x32_bf16 v[88:91], v[100:103], v[148:151], v[88:91]
    ds_read_b128 v[212:215], v13 offset:2560
    v_mfma_f32_16x16x32_bf16 v[92:95], v[104:107], v[148:151], v[92:95]
    v_mfma_f32_16x16x32_bf16 v[84:87], v[116:119], v[128:131], v[84:87]
    ds_read2_b32 v[184:185], v224 offset0:128 offset1:129
    v_mfma_f32_16x16x32_bf16 v[88:91], v[116:119], v[132:135], v[88:91]
    ds_read2_b32 v[186:187], v224 offset0:130 offset1:131
    v_mfma_f32_16x16x32_bf16 v[92:95], v[116:119], v[136:139], v[92:95]
    v_mfma_f32_16x16x32_bf16 v[88:91], v[96:99], v[152:155], v[88:91]
    ds_read_b128 v[216:219], v13 offset:3072
    v_mfma_f32_16x16x32_bf16 v[92:95], v[100:103], v[152:155], v[92:95]
    ds_read2_b32 v[188:189], v224 offset0:0 offset1:1
    v_mfma_f32_16x16x32_bf16 v[88:91], v[120:123], v[128:131], v[88:91]
    v_mfma_f32_16x16x32_bf16 v[92:95], v[120:123], v[132:135], v[92:95]
    ds_read2_b32 v[190:191], v224 offset0:2 offset1:3
    v_mfma_f32_16x16x32_bf16 v[92:95], v[96:99], v[156:159], v[92:95]
    ds_read_b128 v[220:223], v13 offset:3584
    v_mfma_f32_16x16x32_bf16 v[92:95], v[124:127], v[128:131], v[92:95]
    v_subrev_u32 v224, 128, v224
    v_subrev_u32 v225, 128, v225
    v_subrev_u32 v226, 128, v226
    v_subrev_u32 v227, 128, v227
    v_subrev_u32 v13, 128, v13
    s_waitcnt lgkmcnt(0)
    v_mfma_f32_16x16x32_bf16 v[64:67], v[160:163], v[192:195], v[64:67]
    ds_read2_b32 v[96:97], v227 offset0:144 offset1:145
    v_mfma_f32_16x16x32_bf16 v[68:71], v[160:163], v[196:199], v[68:71]
    ds_read2_b32 v[98:99], v227 offset0:146 offset1:147
    v_mfma_f32_16x16x32_bf16 v[68:71], v[164:167], v[192:195], v[68:71]
    v_mfma_f32_16x16x32_bf16 v[72:75], v[164:167], v[196:199], v[72:75]
    ds_read_b128 v[128:131], v13 offset:64
    v_mfma_f32_16x16x32_bf16 v[72:75], v[160:163], v[200:203], v[72:75]
    ds_read2_b32 v[100:101], v227 offset0:16 offset1:17
    v_mfma_f32_16x16x32_bf16 v[76:79], v[164:167], v[200:203], v[76:79]
    v_mfma_f32_16x16x32_bf16 v[72:75], v[168:171], v[192:195], v[72:75]
    ds_read2_b32 v[102:103], v227 offset0:18 offset1:19
    v_mfma_f32_16x16x32_bf16 v[76:79], v[168:171], v[196:199], v[76:79]
    ds_read_b128 v[132:135], v13 offset:576
    v_mfma_f32_16x16x32_bf16 v[80:83], v[168:171], v[200:203], v[80:83]
    v_mfma_f32_16x16x32_bf16 v[76:79], v[160:163], v[204:207], v[76:79]
    ds_read2_b32 v[104:105], v226 offset0:144 offset1:145
    v_mfma_f32_16x16x32_bf16 v[80:83], v[164:167], v[204:207], v[80:83]
    ds_read2_b32 v[106:107], v226 offset0:146 offset1:147
    v_mfma_f32_16x16x32_bf16 v[84:87], v[168:171], v[204:207], v[84:87]
    v_mfma_f32_16x16x32_bf16 v[76:79], v[172:175], v[192:195], v[76:79]
    ds_read_b128 v[136:139], v13 offset:1088
    v_mfma_f32_16x16x32_bf16 v[80:83], v[172:175], v[196:199], v[80:83]
    ds_read2_b32 v[108:109], v226 offset0:16 offset1:17
    v_mfma_f32_16x16x32_bf16 v[84:87], v[172:175], v[200:203], v[84:87]
    v_mfma_f32_16x16x32_bf16 v[88:91], v[172:175], v[204:207], v[88:91]
    ds_read2_b32 v[110:111], v226 offset0:18 offset1:19
    v_mfma_f32_16x16x32_bf16 v[80:83], v[160:163], v[208:211], v[80:83]
    ds_read_b128 v[140:143], v13 offset:1600
    v_mfma_f32_16x16x32_bf16 v[84:87], v[164:167], v[208:211], v[84:87]
    v_mfma_f32_16x16x32_bf16 v[88:91], v[168:171], v[208:211], v[88:91]
    ds_read2_b32 v[112:113], v225 offset0:144 offset1:145
    v_mfma_f32_16x16x32_bf16 v[92:95], v[172:175], v[208:211], v[92:95]
    ds_read2_b32 v[114:115], v225 offset0:146 offset1:147
    v_mfma_f32_16x16x32_bf16 v[80:83], v[176:179], v[192:195], v[80:83]
    v_mfma_f32_16x16x32_bf16 v[84:87], v[176:179], v[196:199], v[84:87]
    ds_read_b128 v[144:147], v13 offset:2112
    v_mfma_f32_16x16x32_bf16 v[88:91], v[176:179], v[200:203], v[88:91]
    ds_read2_b32 v[116:117], v225 offset0:16 offset1:17
    v_mfma_f32_16x16x32_bf16 v[92:95], v[176:179], v[204:207], v[92:95]
    v_mfma_f32_16x16x32_bf16 v[84:87], v[160:163], v[212:215], v[84:87]
    ds_read2_b32 v[118:119], v225 offset0:18 offset1:19
    v_mfma_f32_16x16x32_bf16 v[88:91], v[164:167], v[212:215], v[88:91]
    ds_read_b128 v[148:151], v13 offset:2624
    v_mfma_f32_16x16x32_bf16 v[92:95], v[168:171], v[212:215], v[92:95]
    v_mfma_f32_16x16x32_bf16 v[84:87], v[180:183], v[192:195], v[84:87]
    ds_read2_b32 v[120:121], v224 offset0:144 offset1:145
    v_mfma_f32_16x16x32_bf16 v[88:91], v[180:183], v[196:199], v[88:91]
    ds_read2_b32 v[122:123], v224 offset0:146 offset1:147
    v_mfma_f32_16x16x32_bf16 v[92:95], v[180:183], v[200:203], v[92:95]
    v_mfma_f32_16x16x32_bf16 v[88:91], v[160:163], v[216:219], v[88:91]
    ds_read_b128 v[152:155], v13 offset:3136
    v_mfma_f32_16x16x32_bf16 v[92:95], v[164:167], v[216:219], v[92:95]
    ds_read2_b32 v[124:125], v224 offset0:16 offset1:17
    v_mfma_f32_16x16x32_bf16 v[88:91], v[184:187], v[192:195], v[88:91]
    v_mfma_f32_16x16x32_bf16 v[92:95], v[184:187], v[196:199], v[92:95]
    ds_read2_b32 v[126:127], v224 offset0:18 offset1:19
    v_mfma_f32_16x16x32_bf16 v[92:95], v[160:163], v[220:223], v[92:95]
    ds_read_b128 v[156:159], v13 offset:3648
    v_mfma_f32_16x16x32_bf16 v[92:95], v[188:191], v[192:195], v[92:95]
    s_add_u32 s4, s4, 1
    s_cmp_lt_u32 s4, 2
    s_cbranch_scc1 conv_kernel_cl5
    s_lshl_b32 s58, s50, 13
    s_add_u32 s58, s58, 34048
    v_add_u32 v14, s58, v9
    s_lshl_b32 s58, s50, 11
    s_add_u32 s58, s58, 34048
    v_add_u32 v15, s58, v9
    v_lshlrev_b32 v16, 4, v10
    v_lshl_add_u32 v16, v11, 2, v16
    s_lshl_b32 s58, s50, 9
    v_add_u32 v16, s58, v16
    v_lshlrev_b32 v17, 1, v16
    v_lshlrev_b32 v18, 2, v16
    v_lshrrev_b32 v19, 5, v16
    v_mul_u32_u24 v19, 32768, v19
    v_and_b32 v20, 31, v16
    v_lshl_add_u32 v19, v20, 2, v19
    s_lshl_b32 s58, s48, 6
    s_add_u32 s58, s58, 0x500000
    s_waitcnt lgkmcnt(0)
    ds_read_b64 v[112:113], v17 offset:17152
    ds_read_b64 v[114:115], v17 offset:21760
    ds_read_b128 v[116:119], v18 offset:25856
    ds_read_b64 v[176:177], v17 offset:17664
    ds_read_b64 v[178:179], v17 offset:22272
    ds_read_b128 v[180:183], v18 offset:26880
    ds_write_b128 v14, v[64:67] offset:0
    ds_write_b128 v14, v[68:71] offset:1024
    ds_write_b128 v14, v[72:75] offset:2048
    ds_write_b128 v14, v[76:79] offset:3072
    ds_write_b128 v14, v[80:83] offset:4096
    ds_write_b128 v14, v[84:87] offset:5120
    ds_write_b128 v14, v[88:91] offset:6144
    ds_write_b128 v14, v[92:95] offset:7168
    s_waitcnt lgkmcnt(0)
    ds_add_u32 v230, v231
    v_mov_b32 v42, s66
    v_mov_b32 v43, s67
    s_lshl_b32 s4, s48, 2
    s_add_u32 s4, s4, 0x1c000
    v_mov_b32 v41, 0
    s_mov_b64 exec, 1
    buffer_store_dwordx2 v[42:43], v41, s[8:11], s4 offen
    s_mov_b64 exec, -1
    v_lshlrev_b32 v122, 16, v112
    v_lshlrev_b32 v123, 16, v114
    v_pk_mul_f32 v[122:123], v[122:123], s[68:69]
    v_and_b32 v130, 0xffff0000, v112
    v_and_b32 v131, 0xffff0000, v114
    v_pk_mul_f32 v[130:131], v[130:131], s[68:69]
    v_lshlrev_b32 v138, 16, v113
    v_lshlrev_b32 v139, 16, v115
    v_pk_mul_f32 v[138:139], v[138:139], s[68:69]
    v_and_b32 v146, 0xffff0000, v113
    v_and_b32 v147, 0xffff0000, v115
    v_pk_mul_f32 v[146:147], v[146:147], s[68:69]
    v_lshlrev_b32 v186, 16, v176
    v_lshlrev_b32 v187, 16, v178
    v_pk_mul_f32 v[186:187], v[186:187], s[68:69]
    v_and_b32 v194, 0xffff0000, v176
    v_and_b32 v195, 0xffff0000, v178
    v_pk_mul_f32 v[194:195], v[194:195], s[68:69]
    v_lshlrev_b32 v202, 16, v177
    v_lshlrev_b32 v203, 16, v179
    v_pk_mul_f32 v[202:203], v[202:203], s[68:69]
    v_and_b32 v210, 0xffff0000, v177
    v_and_b32 v211, 0xffff0000, v179
    v_pk_mul_f32 v[210:211], v[210:211], s[68:69]
    v_cvt_pk_bf16_f32 v127, v122, v123
    v_lshlrev_b32 v122, 16, v127
    v_and_b32 v123, 0xffff0000, v127
    v_lshlrev_b32 v124, 16, v116
    v_and_b32 v125, 0xffff0000, v116
    v_cvt_pk_bf16_f32 v135, v130, v131
    v_lshlrev_b32 v130, 16, v135
    v_and_b32 v131, 0xffff0000, v135
    v_lshlrev_b32 v132, 16, v117
    v_and_b32 v133, 0xffff0000, v117
    v_cvt_pk_bf16_f32 v143, v138, v139
    v_lshlrev_b32 v138, 16, v143
    v_and_b32 v139, 0xffff0000, v143
    v_lshlrev_b32 v140, 16, v118
    v_and_b32 v141, 0xffff0000, v118
    v_cvt_pk_bf16_f32 v151, v146, v147
    v_lshlrev_b32 v146, 16, v151
    v_and_b32 v147, 0xffff0000, v151
    v_lshlrev_b32 v148, 16, v119
    v_and_b32 v149, 0xffff0000, v119
    v_cvt_pk_bf16_f32 v191, v186, v187
    v_lshlrev_b32 v186, 16, v191
    v_and_b32 v187, 0xffff0000, v191
    v_lshlrev_b32 v188, 16, v180
    v_and_b32 v189, 0xffff0000, v180
    v_cvt_pk_bf16_f32 v199, v194, v195
    v_lshlrev_b32 v194, 16, v199
    v_and_b32 v195, 0xffff0000, v199
    v_lshlrev_b32 v196, 16, v181
    v_and_b32 v197, 0xffff0000, v181
    v_cvt_pk_bf16_f32 v207, v202, v203
    v_lshlrev_b32 v202, 16, v207
    v_and_b32 v203, 0xffff0000, v207
    v_lshlrev_b32 v204, 16, v182
    v_and_b32 v205, 0xffff0000, v182
    v_cvt_pk_bf16_f32 v215, v210, v211
    v_lshlrev_b32 v210, 16, v215
    v_and_b32 v211, 0xffff0000, v215
    v_lshlrev_b32 v212, 16, v183
    v_and_b32 v213, 0xffff0000, v183
conv_kernel_s46:
    ds_read_b32 v232, v230
    s_waitcnt lgkmcnt(0)
    v_readfirstlane_b32 s97, v232
    s_nop 0
    s_cmp_lt_u32 s97, 4
    s_cbranch_scc1 conv_kernel_s46
    ds_read_b128 v[96:99], v15 offset:0
    ds_read_b128 v[100:103], v15 offset:8192
    ds_read_b128 v[104:107], v15 offset:16384
    ds_read_b128 v[108:111], v15 offset:24576
    ds_read_b128 v[160:163], v15 offset:1024
    ds_read_b128 v[164:167], v15 offset:9216
    ds_read_b128 v[168:171], v15 offset:17408
    ds_read_b128 v[172:175], v15 offset:25600
    s_waitcnt lgkmcnt(4)
    v_add_f32 v120, v96, v100
    v_add_f32 v121, v104, v108
    v_add_f32 v128, v97, v101
    v_add_f32 v129, v105, v109
    v_add_f32 v136, v98, v102
    v_add_f32 v137, v106, v110
    v_add_f32 v144, v99, v103
    v_add_f32 v145, v107, v111
    s_waitcnt lgkmcnt(0)
    v_add_f32 v184, v160, v164
    v_add_f32 v185, v168, v172
    v_add_f32 v192, v161, v165
    v_add_f32 v193, v169, v173
    v_add_f32 v200, v162, v166
    v_add_f32 v201, v170, v174
    v_add_f32 v208, v163, v167
    v_add_f32 v209, v171, v175
    v_cvt_pk_bf16_f32 v126, v120, v121
    v_lshlrev_b32 v120, 16, v126
    v_and_b32 v121, 0xffff0000, v126
    v_pk_add_f32 v[120:121], v[120:121], v[122:123]
    v_cvt_pk_bf16_f32 v134, v128, v129
    v_lshlrev_b32 v128, 16, v134
    v_and_b32 v129, 0xffff0000, v134
    v_pk_add_f32 v[128:129], v[128:129], v[130:131]
    v_cvt_pk_bf16_f32 v142, v136, v137
    v_lshlrev_b32 v136, 16, v142
    v_and_b32 v137, 0xffff0000, v142
    v_pk_add_f32 v[136:137], v[136:137], v[138:139]
    v_cvt_pk_bf16_f32 v150, v144, v145
    v_lshlrev_b32 v144, 16, v150
    v_and_b32 v145, 0xffff0000, v150
    v_pk_add_f32 v[144:145], v[144:145], v[146:147]
    v_cvt_pk_bf16_f32 v190, v184, v185
    v_lshlrev_b32 v184, 16, v190
    v_and_b32 v185, 0xffff0000, v190
    v_pk_add_f32 v[184:185], v[184:185], v[186:187]
    v_cvt_pk_bf16_f32 v198, v192, v193
    v_lshlrev_b32 v192, 16, v198
    v_and_b32 v193, 0xffff0000, v198
    v_pk_add_f32 v[192:193], v[192:193], v[194:195]
    v_cvt_pk_bf16_f32 v206, v200, v201
    v_lshlrev_b32 v200, 16, v206
    v_and_b32 v201, 0xffff0000, v206
    v_pk_add_f32 v[200:201], v[200:201], v[202:203]
    v_cvt_pk_bf16_f32 v214, v208, v209
    v_lshlrev_b32 v208, 16, v214
    v_and_b32 v209, 0xffff0000, v214
    v_pk_add_f32 v[208:209], v[208:209], v[210:211]
    v_cvt_pk_bf16_f32 v126, v120, v121
    v_lshlrev_b32 v120, 16, v126
    v_and_b32 v121, 0xffff0000, v126
    v_pk_mul_f32 v[120:121], v[120:121], s[64:65]
    v_cvt_pk_bf16_f32 v134, v128, v129
    v_lshlrev_b32 v128, 16, v134
    v_and_b32 v129, 0xffff0000, v134
    v_pk_mul_f32 v[128:129], v[128:129], s[64:65]
    v_cvt_pk_bf16_f32 v142, v136, v137
    v_lshlrev_b32 v136, 16, v142
    v_and_b32 v137, 0xffff0000, v142
    v_pk_mul_f32 v[136:137], v[136:137], s[64:65]
    v_cvt_pk_bf16_f32 v150, v144, v145
    v_lshlrev_b32 v144, 16, v150
    v_and_b32 v145, 0xffff0000, v150
    v_pk_mul_f32 v[144:145], v[144:145], s[64:65]
    v_cvt_pk_bf16_f32 v190, v184, v185
    v_lshlrev_b32 v184, 16, v190
    v_and_b32 v185, 0xffff0000, v190
    v_pk_mul_f32 v[184:185], v[184:185], s[64:65]
    v_cvt_pk_bf16_f32 v198, v192, v193
    v_lshlrev_b32 v192, 16, v198
    v_and_b32 v193, 0xffff0000, v198
    v_pk_mul_f32 v[192:193], v[192:193], s[64:65]
    v_cvt_pk_bf16_f32 v206, v200, v201
    v_lshlrev_b32 v200, 16, v206
    v_and_b32 v201, 0xffff0000, v206
    v_pk_mul_f32 v[200:201], v[200:201], s[64:65]
    v_cvt_pk_bf16_f32 v214, v208, v209
    v_lshlrev_b32 v208, 16, v214
    v_and_b32 v209, 0xffff0000, v214
    v_pk_mul_f32 v[208:209], v[208:209], s[64:65]
    v_cvt_pk_bf16_f32 v126, v120, v121
    v_lshlrev_b32 v120, 16, v126
    v_and_b32 v121, 0xffff0000, v126
    v_pk_add_f32 v[120:121], v[120:121], v[124:125]
    v_cvt_pk_bf16_f32 v152, v120, v121
    v_cvt_pk_bf16_f32 v134, v128, v129
    v_lshlrev_b32 v128, 16, v134
    v_and_b32 v129, 0xffff0000, v134
    v_pk_add_f32 v[128:129], v[128:129], v[132:133]
    v_cvt_pk_bf16_f32 v153, v128, v129
    v_cvt_pk_bf16_f32 v142, v136, v137
    v_lshlrev_b32 v136, 16, v142
    v_and_b32 v137, 0xffff0000, v142
    v_pk_add_f32 v[136:137], v[136:137], v[140:141]
    v_cvt_pk_bf16_f32 v154, v136, v137
    v_cvt_pk_bf16_f32 v150, v144, v145
    v_lshlrev_b32 v144, 16, v150
    v_and_b32 v145, 0xffff0000, v150
    v_pk_add_f32 v[144:145], v[144:145], v[148:149]
    v_cvt_pk_bf16_f32 v155, v144, v145
    buffer_store_dwordx4 v[152:155], v19, s[8:11], s58 offen
    s_add_u32 s58, s58, 262144
    v_cvt_pk_bf16_f32 v190, v184, v185
    v_lshlrev_b32 v184, 16, v190
    v_and_b32 v185, 0xffff0000, v190
    v_pk_add_f32 v[184:185], v[184:185], v[188:189]
    v_cvt_pk_bf16_f32 v216, v184, v185
    v_cvt_pk_bf16_f32 v198, v192, v193
    v_lshlrev_b32 v192, 16, v198
    v_and_b32 v193, 0xffff0000, v198
    v_pk_add_f32 v[192:193], v[192:193], v[196:197]
    v_cvt_pk_bf16_f32 v217, v192, v193
    v_cvt_pk_bf16_f32 v206, v200, v201
    v_lshlrev_b32 v200, 16, v206
    v_and_b32 v201, 0xffff0000, v206
    v_pk_add_f32 v[200:201], v[200:201], v[204:205]
    v_cvt_pk_bf16_f32 v218, v200, v201
    v_cvt_pk_bf16_f32 v214, v208, v209
    v_lshlrev_b32 v208, 16, v214
    v_and_b32 v209, 0xffff0000, v214
    v_pk_add_f32 v[208:209], v[208:209], v[212:213]
    v_cvt_pk_bf16_f32 v219, v208, v209
    buffer_store_dwordx4 v[216:219], v19, s[8:11], s58 offen
    s_add_u32 s58, s58, 262144
    s_endpgm
conv_kernel_P2_2:
    v_mov_b32 v44, 0
    v_mov_b32 v45, 0
    v_mov_b32 v46, 0
    v_mov_b32 v47, 0
    v_lshrrev_b32 v10, 5, v100
    v_mul_u32_u24 v10, 4608, v10
    v_and_b32 v11, 31, v100
    v_lshl_add_u32 v10, v11, 4, v10
    v_add_u32 v10, 16640, v10
    v_bfe_u32 v11, v100, 1, 2
    v_mul_u32_u24 v11, 4160, v11
    v_and_b32 v12, 1, v100
    v_lshl_add_u32 v11, v12, 4, v11
    v_add_u32 v11, 4096, v11
    v_cmp_gt_u32 vcc, 64, v100
    s_nop 1
    v_cndmask_b32 v10, v11, v10, vcc
    v_mov_b32 v11, 118656
    v_cmp_gt_u32 vcc, 72, v100
    s_nop 1
    v_cndmask_b32 v10, v11, v10, vcc
    ds_write_b128 v10, v[44:47]
    v_lshlrev_b32 v150, 4, v140
    v_sub_u32 v150, 2032, v150
    v_or_b32 v151, 128, v150
    v_ffbh_u32 v151, v151
    v_sub_u32 v151, 24, v151
    v_lshrrev_b32 v152, v151, v150
    v_lshl_add_u32 v152, v151, 7, v152
    v_lshl_add_u32 v152, v152, 1, s64
    v_lshlrev_b32 v151, 3, v151
    s_mov_b32 s4, 0x408101e
    v_bfe_u32 v153, s4, v151, 8
    v_add_u32 v160, v152, v153
    s_mov_b32 s5, 0x4080e1c
    v_bfe_u32 v153, s5, v151, 8
    v_add_u32 v161, v152, v153
    s_mov_b32 s4, 0x4060c1a
    v_bfe_u32 v153, s4, v151, 8
    v_add_u32 v162, v152, v153
    s_mov_b32 s5, 0x4060c18
    v_bfe_u32 v153, s5, v151, 8
    v_add_u32 v163, v152, v153
    s_mov_b32 s4, 0x2060c16
    v_bfe_u32 v153, s4, v151, 8
    v_add_u32 v164, v152, v153
    s_mov_b32 s5, 0x2040a14
    v_bfe_u32 v153, s5, v151, 8
    v_add_u32 v165, v152, v153
    s_mov_b32 s4, 0x2040812
    v_bfe_u32 v153, s4, v151, 8
    v_add_u32 v166, v152, v153
    s_mov_b32 s5, 0x2040810
    v_bfe_u32 v153, s5, v151, 8
    v_add_u32 v167, v152, v153
    s_mov_b32 s4, 0x204080e
    v_bfe_u32 v153, s4, v151, 8
    v_add_u32 v168, v152, v153
    s_mov_b32 s5, 0x204060c
    v_bfe_u32 v153, s5, v151, 8
    v_add_u32 v169, v152, v153
    s_mov_b32 s4, 0x202040a
    v_bfe_u32 v153, s4, v151, 8
    v_add_u32 v170, v152, v153
    s_mov_b32 s5, 0x20408
    v_bfe_u32 v153, s5, v151, 8
    v_add_u32 v171, v152, v153
    s_mov_b32 s4, 0x20406
    v_bfe_u32 v153, s4, v151, 8
    v_add_u32 v172, v152, v153
    s_mov_b32 s5, 0x204
    v_bfe_u32 v153, s5, v151, 8
    v_add_u32 v173, v152, v153
    s_mov_b32 s4, 0x2
    v_bfe_u32 v153, s4, v151, 8
    v_add_u32 v174, v152, v153
    s_mov_b32 s5, 0x0
    v_bfe_u32 v153, s5, v151, 8
    v_add_u32 v175, v152, v153
    v_cmp_gt_u32 vcc, 257, v150
    v_subrev_u32 v153, 2, v152
    s_nop 0
    v_cndmask_b32 v176, v152, v153, vcc
    s_sub_u32 s4, s64, 4
    v_mov_b32 v154, s4
    v_mov_b32 v153, 0
    ds_write_b32 v154, v153
    v_add_u32 v141, s64, v141
    v_add_u32 v142, s64, v9
    s_waitcnt vmcnt(10)
    ds_write_b128 v142, v[144:147]
    ds_write_b128 v141, v[196:199]
    s_waitcnt lgkmcnt(0)
    ds_read_u16 v180, v160
    ds_read_u16 v181, v161
    ds_read_u16 v182, v162
    ds_read_u16 v183, v163
    ds_read_u16 v184, v164
    ds_read_u16 v185, v165
    ds_read_u16 v186, v166
    ds_read_u16 v187, v167
    ds_read_u16 v188, v168
    ds_read_u16 v189, v169
    ds_read_u16 v190, v170
    ds_read_u16 v191, v171
    ds_read_u16 v192, v172
    ds_read_u16 v193, v173
    ds_read_u16 v194, v174
    ds_read_u16 v195, v175
    ds_read_u16 v196, v176
    s_mul_i32 s4, s56, 8320
    v_lshlrev_b32 v141, 5, v140
    v_add_u32 v141, s4, v141
    s_waitcnt lgkmcnt(0)
    v_lshl_or_b32 v144, v181, 16, v180
    v_lshl_or_b32 v152, v182, 16, v181
    v_lshl_or_b32 v145, v183, 16, v182
    v_lshl_or_b32 v153, v184, 16, v183
    v_lshl_or_b32 v146, v185, 16, v184
    v_lshl_or_b32 v154, v186, 16, v185
    v_lshl_or_b32 v147, v187, 16, v186
    v_lshl_or_b32 v155, v188, 16, v187
    v_lshl_or_b32 v148, v189, 16, v188
    v_lshl_or_b32 v156, v190, 16, v189
    v_lshl_or_b32 v149, v191, 16, v190
    v_lshl_or_b32 v157, v192, 16, v191
    v_lshl_or_b32 v150, v193, 16, v192
    v_lshl_or_b32 v158, v194, 16, v193
    v_lshl_or_b32 v151, v195, 16, v194
    v_lshl_or_b32 v159, v196, 16, v195
    ds_write_b128 v141, v[144:147] offset:0
    ds_write_b128 v141, v[148:151] offset:16
    ds_write_b128 v141, v[152:155] offset:4160
    ds_write_b128 v141, v[156:159] offset:4176
    s_waitcnt lgkmcnt(0)
    s_barrier
    s_and_b32 s51, s50, 3
    v_mul_u32_u24 v11, 160, v101
    v_lshl_add_u32 v11, v102, 4, v11
    v_add_u32 v11, 66816, v11
    v_lshrrev_b32 v40, 4, v4
    v_bfe_u32 v41, v4, 2, 2
    v_and_b32 v42, 3, v4
    v_and_b32 v43, 1, v40
    v_lshrrev_b32 v44, 1, v40
    v_lshl_add_u32 v45, v44, 3, v41
    v_mul_u32_u24 v45, 160, v45
    v_mul_u32_u24 v46, 10368, v43
    v_add_u32 v45, v45, v46
    v_lshl_add_u32 v45, v42, 3, v45
    s_lshl_b32 s54, s51, 5
    s_add_u32 s54, s54, 66816
    v_add_u32 v45, s54, v45
    v_lshl_add_u32 v46, v44, 2, v41
    s_lshl_b32 s54, s51, 4
    v_add_u32 v46, s54, v46
    v_mul_u32_u24 v46, 160, v46
    v_and_b32 v47, 1, v42
    v_lshl_add_u32 v46, v47, 5, v46
    v_lshl_add_u32 v46, v43, 4, v46
    v_lshrrev_b32 v47, 1, v42
    v_lshl_add_u32 v46, v47, 3, v46
    v_add_u32 v46, 66816, v46
    v_lshrrev_b32 v47, 5, v4
    v_lshlrev_b32 v47, 4, v47
    v_add_u32 v10, 66816, v47
    s_cmp_ge_u32 s2, 224
    s_cbranch_scc1 conv_kernel_end1
    s_waitcnt vmcnt(6)
    v_add_f32_dpp v112, v112, v112 quad_perm:[1,0,3,2] row_mask:0xf bank_mask:0xf
    s_nop 1
    v_add_f32_dpp v112, v112, v112 quad_perm:[2,3,0,1] row_mask:0xf bank_mask:0xf
    s_nop 1
    v_add_f32_dpp v112, v112, v112 row_half_mirror row_mask:0xf bank_mask:0xf
    v_add_f32_dpp v113, v113, v113 quad_perm:[1,0,3,2] row_mask:0xf bank_mask:0xf
    s_nop 1
    v_add_f32_dpp v113, v113, v113 quad_perm:[2,3,0,1] row_mask:0xf bank_mask:0xf
    s_nop 1
    v_add_f32_dpp v113, v113, v113 row_half_mirror row_mask:0xf bank_mask:0xf
    v_add_f32_dpp v114, v114, v114 quad_perm:[1,0,3,2] row_mask:0xf bank_mask:0xf
    s_nop 1
    v_add_f32_dpp v114, v114, v114 quad_perm:[2,3,0,1] row_mask:0xf bank_mask:0xf
    s_nop 1
    v_add_f32_dpp v114, v114, v114 row_half_mirror row_mask:0xf bank_mask:0xf
    v_add_f32_dpp v115, v115, v115 quad_perm:[1,0,3,2] row_mask:0xf bank_mask:0xf
    s_nop 1
    v_add_f32_dpp v115, v115, v115 quad_perm:[2,3,0,1] row_mask:0xf bank_mask:0xf
    s_nop 1
    v_add_f32_dpp v115, v115, v115 row_half_mirror row_mask:0xf bank_mask:0xf
    v_cvt_pk_bf16_f32 v112, v112, v112
    v_and_b32 v112, 0xffff0000, v112
    v_cvt_pk_bf16_f32 v113, v113, v113
    v_and_b32 v113, 0xffff0000, v113
    v_cvt_pk_bf16_f32 v114, v114, v114
    v_and_b32 v114, 0xffff0000, v114
    v_cvt_pk_bf16_f32 v115, v115, v115
    v_and_b32 v115, 0xffff0000, v115
    v_add_f32 v114, 1.0, v114
    v_cvt_pk_bf16_f32 v114, v114, v114
    v_and_b32 v114, 0xffff0000, v114
    v_add_f32 v115, 1.0, v115
    v_cvt_pk_bf16_f32 v115, v115, v115
    v_and_b32 v115, 0xffff0000, v115
    v_lshlrev_b32 v49, 1, v101
    v_add_u32 v49, 66816, v49
    ds_write_b16_d16_hi v49, v112 offset:51712
    ds_write_b16_d16_hi v49, v113 offset:51776
    s_waitcnt vmcnt(5)
    ds_write_b128 v11, v[116:119] offset:0
    v_lshlrev_b32 v12, 16, v116
    v_and_b32 v13, 0xffff0000, v116
    v_mul_f32 v12, v114, v12
    v_mul_f32 v13, v114, v13
    v_cvt_pk_bf16_f32 v52, v12, v13
    v_lshlrev_b32 v50, 16, v117
    v_and_b32 v51, 0xffff0000, v117
    v_mul_f32 v50, v114, v50
    v_mul_f32 v51, v114, v51
    v_cvt_pk_bf16_f32 v53, v50, v51
    v_lshlrev_b32 v12, 16, v118
    v_and_b32 v13, 0xffff0000, v118
    v_mul_f32 v12, v114, v12
    v_mul_f32 v13, v114, v13
    v_cvt_pk_bf16_f32 v54, v12, v13
    v_lshlrev_b32 v50, 16, v119
    v_and_b32 v51, 0xffff0000, v119
    v_mul_f32 v50, v114, v50
    v_mul_f32 v51, v114, v51
    v_cvt_pk_bf16_f32 v55, v50, v51
    ds_write_b128 v11, v[52:55] offset:20736
    s_waitcnt vmcnt(4)
    ds_write_b128 v11, v[120:123] offset:5120
    v_lshlrev_b32 v12, 16, v120
    v_and_b32 v13, 0xffff0000, v120
    v_mul_f32 v12, v115, v12
    v_mul_f32 v13, v115, v13
    v_cvt_pk_bf16_f32 v56, v12, v13
    v_lshlrev_b32 v50, 16, v121
    v_and_b32 v51, 0xffff0000, v121
    v_mul_f32 v50, v115, v50
    v_mul_f32 v51, v115, v51
    v_cvt_pk_bf16_f32 v57, v50, v51
    v_lshlrev_b32 v12, 16, v122
    v_and_b32 v13, 0xffff0000, v122
    v_mul_f32 v12, v115, v12
    v_mul_f32 v13, v115, v13
    v_cvt_pk_bf16_f32 v58, v12, v13
    v_lshlrev_b32 v50, 16, v123
    v_and_b32 v51, 0xffff0000, v123
    v_mul_f32 v50, v115, v50
    v_mul_f32 v51, v115, v51
    v_cvt_pk_bf16_f32 v59, v50, v51
    ds_write_b128 v11, v[56:59] offset:25856
    s_waitcnt vmcnt(3)
    ds_write_b128 v11, v[124:127] offset:10368
    v_lshlrev_b32 v12, 16, v124
    v_and_b32 v13, 0xffff0000, v124
    v_mul_f32 v12, v114, v12
    v_mul_f32 v13, v114, v13
    v_cvt_pk_bf16_f32 v60, v12, v13
    v_lshlrev_b32 v50, 16, v125
    v_and_b32 v51, 0xffff0000, v125
    v_mul_f32 v50, v114, v50
    v_mul_f32 v51, v114, v51
    v_cvt_pk_bf16_f32 v61, v50, v51
    v_lshlrev_b32 v12, 16, v126
    v_and_b32 v13, 0xffff0000, v126
    v_mul_f32 v12, v114, v12
    v_mul_f32 v13, v114, v13
    v_cvt_pk_bf16_f32 v62, v12, v13
    v_lshlrev_b32 v50, 16, v127
    v_and_b32 v51, 0xffff0000, v127
    v_mul_f32 v50, v114, v50
    v_mul_f32 v51, v114, v51
    v_cvt_pk_bf16_f32 v63, v50, v51
    ds_write_b128 v11, v[60:63] offset:31104
    s_waitcnt vmcnt(2)
    ds_write_b128 v11, v[128:131] offset:15488
    v_lshlrev_b32 v12, 16, v128
    v_and_b32 v13, 0xffff0000, v128
    v_mul_f32 v12, v115, v12
    v_mul_f32 v13, v115, v13
    v_cvt_pk_bf16_f32 v64, v12, v13
    v_lshlrev_b32 v50, 16, v129
    v_and_b32 v51, 0xffff0000, v129
    v_mul_f32 v50, v115, v50
    v_mul_f32 v51, v115, v51
    v_cvt_pk_bf16_f32 v65, v50, v51
    v_lshlrev_b32 v12, 16, v130
    v_and_b32 v13, 0xffff0000, v130
    v_mul_f32 v12, v115, v12
    v_mul_f32 v13, v115, v13
    v_cvt_pk_bf16_f32 v66, v12, v13
    v_lshlrev_b32 v50, 16, v131
    v_and_b32 v51, 0xffff0000, v131
    v_mul_f32 v50, v115, v50
    v_mul_f32 v51, v115, v51
    v_cvt_pk_bf16_f32 v67, v50, v51
    ds_write_b128 v11, v[64:67] offset:36224
    s_waitcnt vmcnt(0)
    ds_write_b128 v11, v[132:135] offset:41472
    ds_write_b128 v11, v[136:139] offset:46592
    v_mov_b32 v68, 0x3f803f80
    v_mov_b32 v69, 0x3f803f80
    v_mov_b32 v70, 0x3f803f80
    v_mov_b32 v71, 0x3f803f80
    s_waitcnt lgkmcnt(0)
    ds_add_u32 v230, v231 offset:4
conv_kernel_s57:
    ds_read_b32 v232, v230 offset:4
    s_waitcnt lgkmcnt(0)
    v_readfirstlane_b32 s97, v232
    s_nop 0
    s_cmp_lt_u32 s97, 4
    s_cbranch_scc1 conv_kernel_s57
    ds_read_b64_tr_b16 v[72:73], v45 offset:20736
    ds_read_b64_tr_b16 v[74:75], v45 offset:21376
    ds_read_b64_tr_b16 v[76:77], v45 offset:23296
    ds_read_b64_tr_b16 v[78:79], v45 offset:23936
    ds_read_b64_tr_b16 v[80:81], v45 offset:25856
    ds_read_b64_tr_b16 v[82:83], v45 offset:26496
    ds_read_b64_tr_b16 v[84:85], v45 offset:28416
    ds_read_b64_tr_b16 v[86:87], v45 offset:29056
    ds_read_b64_tr_b16 v[120:121], v46 offset:41472
    ds_read_b64_tr_b16 v[122:123], v46 offset:42752
    ds_read_b64_tr_b16 v[124:125], v46 offset:41536
    ds_read_b64_tr_b16 v[126:127], v46 offset:42816
    s_lshl_b32 s54, s53, 2
    s_add_u32 s54, s54, s51
    s_mul_i32 s55, s54, 9363
    s_lshr_b32 s55, s55, 16
    s_mul_i32 s56, s55, 7
    s_sub_u32 s56, s54, s56
    s_lshl_b32 s55, s55, 5
    s_lshl_b32 s57, s52, 2
    s_add_u32 s55, s55, s57
    s_mul_i32 s55, s55, 7
    s_add_u32 s55, s55, s56
    s_lshl_b32 s55, s55, 10
    s_add_u32 s55, s55, 0x780000
    s_waitcnt lgkmcnt(0)
    ds_read_b64_tr_b16 v[88:89], v45 offset:0
    ds_read_b64_tr_b16 v[90:91], v45 offset:640
    ds_read_b128 v[104:107], v10 offset:51712
    ds_read_b64_tr_b16 v[92:93], v45 offset:2560
    ds_read_b64_tr_b16 v[94:95], v45 offset:3200
    ds_read_b128 v[108:111], v10 offset:51744
    ds_read_b64_tr_b16 v[96:97], v45 offset:5120
    ds_read_b64_tr_b16 v[98:99], v45 offset:5760
    ds_read_b128 v[112:115], v10 offset:51776
    ds_read_b64_tr_b16 v[100:101], v45 offset:7680
    ds_read_b64_tr_b16 v[102:103], v45 offset:8320
    ds_read_b128 v[116:119], v10 offset:51808
    buffer_store_dwordx4 v[72:75], v9, s[8:11], s55 offen sc1
    s_add_u32 s55, s55, 7168
    buffer_store_dwordx4 v[76:79], v9, s[8:11], s55 offen sc1
    s_add_u32 s55, s55, 7168
    buffer_store_dwordx4 v[80:83], v9, s[8:11], s55 offen sc1
    s_add_u32 s55, s55, 7168
    buffer_store_dwordx4 v[84:87], v9, s[8:11], s55 offen sc1
    s_mul_i32 s56, s90, 224
    s_lshl_b32 s57, s91, 2
    s_add_u32 s56, s56, s57
    s_add_u32 s56, s56, s51
    s_lshl_b32 s56, s56, 10
    s_add_u32 s56, s56, 0xb00000
    s_add_u32 s57, s56, 114688
    buffer_store_dwordx4 v[120:123], v9, s[8:11], s56 offen sc1
    buffer_store_dwordx4 v[124:127], v9, s[8:11], s57 offen sc1
    v_mfma_f32_32x32x16_bf16 v[128:143], v[72:75], v[68:71], 0
    v_mfma_f32_32x32x16_bf16 v[128:143], v[76:79], v[68:71], v[128:143]
    v_mfma_f32_32x32x16_bf16 v[128:143], v[80:83], v[68:71], v[128:143]
    v_mfma_f32_32x32x16_bf16 v[128:143], v[84:87], v[68:71], v[128:143]
    s_waitcnt lgkmcnt(0)
    v_mfma_f32_32x32x16_bf16 v[144:159], v[88:91], v[104:107], 0
    v_mfma_f32_32x32x16_bf16 v[144:159], v[92:95], v[108:111], v[144:159]
    v_mfma_f32_32x32x16_bf16 v[144:159], v[96:99], v[112:115], v[144:159]
    v_mfma_f32_32x32x16_bf16 v[144:159], v[100:103], v[116:119], v[144:159]
    s_mul_i32 s56, s52, 112
    s_add_u32 s56, s56, s54
    s_lshl_b32 s56, s56, 8
    s_add_u32 s56, s56, 0x20000
    v_and_b32 v50, 31, v4
    v_cmp_eq_u32 vcc, 0, v50
    s_nop 0
    s_and_saveexec_b64 s[58:59], vcc
    buffer_store_dwordx4 v[128:131], v47, s[8:11], s56 offen offset:0
    buffer_store_dwordx4 v[132:135], v47, s[8:11], s56 offen offset:32
    buffer_store_dwordx4 v[136:139], v47, s[8:11], s56 offen offset:64
    buffer_store_dwordx4 v[140:143], v47, s[8:11], s56 offen offset:96
    buffer_store_dwordx4 v[144:147], v47, s[8:11], s56 offen offset:128
    buffer_store_dwordx4 v[148:151], v47, s[8:11], s56 offen offset:160
    buffer_store_dwordx4 v[152:155], v47, s[8:11], s56 offen offset:192
    buffer_store_dwordx4 v[156:159], v47, s[8:11], s56 offen offset:224
conv_kernel_end1:
    s_endpgm
.globl ffn_kernel
.p2align 8
.type ffn_kernel,@function
ffn_kernel:
    s_getpc_b64 s[28:29]
    s_load_dwordx2 s[46:47], s[0:1], 120
    s_load_dwordx2 s[42:43], s[0:1], 104
    s_cmp_ge_u32 s2, 256
    s_cbranch_scc1 ffn_kernel_end1
    s_and_b32 s3, s2, 7
    s_lshr_b32 s4, s2, 3
    s_and_b32 s48, s3, 1
    s_lshl_b32 s48, s48, 3
    s_and_b32 s5, s4, 7
    s_add_u32 s48, s48, s5
    s_lshr_b32 s49, s3, 1
    s_lshl_b32 s49, s49, 2
    s_lshr_b32 s5, s4, 3
    s_add_u32 s49, s49, s5
    v_and_b32 v1, 63, v0
    v_lshrrev_b32 v2, 6, v0
    s_nop 0
    v_readfirstlane_b32 s50, v2
    v_lshlrev_b32 v3, 4, v1
    v_lshrrev_b32 v4, 5, v1
    v_and_b32 v5, 31, v1
    s_and_b32 s51, s50, 3
    s_lshl_b32 s16, s3, 2
    s_lshr_b32 s5, s4, 3
    s_add_u32 s16, s16, s5
    s_and_b32 s17, s4, 7
    s_lshl_b32 s18, s17, 1
    s_lshr_b32 s5, s51, 1
    s_add_u32 s18, s18, s5
    s_xor_b32 s19, s18, 1
    s_lshl_b32 s20, s16, 1
    s_and_b32 s5, s51, 1
    s_add_u32 s20, s20, s5
    s_xor_b32 s21, s20, 1
    s_mul_i32 s22, s51, 28
    s_mul_i32 s24, s18, 112
    s_add_u32 s24, s24, s22
    s_lshl_b32 s24, s24, 10
    s_add_u32 s24, s24, 0xb00000
    s_mul_i32 s25, s19, 112
    s_add_u32 s25, s25, s22
    s_lshl_b32 s25, s25, 10
    s_add_u32 s25, s25, 0xb00000
    s_mul_i32 s26, s20, 112
    s_add_u32 s26, s26, s22
    s_lshl_b32 s26, s26, 10
    s_add_u32 s26, s26, 0xcc0000
    s_mul_i32 s27, s21, 112
    s_add_u32 s27, s27, s22
    s_lshl_b32 s27, s27, 10
    s_add_u32 s27, s27, 0xcc0000
    s_cmp_lt_u32 s50, 4
    s_cbranch_scc1 ffn_kernel_H2_M
    s_and_b32 s67, s48, 7
    s_lshl_b32 s67, s67, 1
    s_and_b32 s5, s49, 3
    s_lshl_b32 s5, s5, 2
    s_add_u32 s67, s67, s5
    s_and_b32 s67, s67, 15
    s_mov_b32 s67, 0
    s_mul_i32 s68, s49, 229376
    s_lshl_b32 s5, s51, 12
    s_add_u32 s68, s68, s5
    s_add_u32 s68, s68, 0x780000
    s_add_u32 s55, s5, 7168
    s_lshl_b32 s69, s48, 2
    s_add_u32 s69, s69, s51
    s_mul_i32 s69, s69, 32768
    s_add_u32 s69, s69, 0x500000
    s_lshl_b32 s5, s51, 11
    s_add_u32 s56, s5, 23552
    s_cmp_eq_u32 s51, 3
    s_cselect_b32 s44, 0x40000000, 0
    s_mov_b32 s64, 0
    v_subrev_u32 v7, 256, v0
    v_lshrrev_b32 v8, 5, v7
    v_lshlrev_b32 v9, 8, v8
    v_lshl_add_u32 v9, v5, 2, v9
    v_lshlrev_b32 v11, 10, v8
    v_lshl_add_u32 v11, v5, 4, v11
    s_mul_i32 s57, s49, 1792
    s_add_u32 s57, s57, 0x20000
    v_cmp_gt_u32 vcc, 480, v0
    s_waitcnt lgkmcnt(0)
    s_mov_b32 s8, s46
    s_mov_b32 s9, s47
    s_mov_b32 s10, 0x15c0000
    s_mov_b32 s11, 0x20000
    s_branch ffn_kernel_sk7
ffn_kernel_dma3:
    s_mul_i32 s54, s67, 14336
    s_add_u32 s54, s54, s68
    s_lshl_b32 s53, s67, 11
    s_add_u32 s53, s53, s69
    s_add_u32 m0, s56, s64
    s_add_u32 s45, s54, s44
    buffer_load_dwordx4 v3, s[8:11], s53 offen lds
    buffer_load_dwordx4 v3, s[8:11], s53 offen offset:1024 lds
    s_add_u32 m0, s55, s64
    s_add_u32 s67, s67, 1
    buffer_load_dwordx4 v3, s[8:11], s54 offen lds
    buffer_load_dwordx4 v3, s[8:11], s54 offen offset:1024 lds
    buffer_load_dwordx4 v3, s[8:11], s45 offen offset:2048 lds
    buffer_load_dwordx4 v3, s[8:11], s45 offen offset:3072 lds
    s_and_b32 s67, s67, 15
    s_add_u32 s64, s64, 24576
    s_cmp_eq_u32 s64, 147456
    s_cselect_b32 s64, 0, s64
    s_setpc_b64 s[30:31]
ffn_kernel_sk7:
    s_call_b64 s[30:31], ffn_kernel_dma3
    s_mov_b64 exec, vcc
    buffer_load_dword v16, v9, s[8:11], s57 offen
    buffer_load_dword v17, v9, s[8:11], s57 offen offset:128
    s_add_u32 s57, s57, 28672
    buffer_load_dword v18, v9, s[8:11], s57 offen
    buffer_load_dword v19, v9, s[8:11], s57 offen offset:128
    s_add_u32 s57, s57, 28672
    buffer_load_dword v20, v9, s[8:11], s57 offen
    buffer_load_dword v21, v9, s[8:11], s57 offen offset:128
    s_add_u32 s57, s57, 28672
    buffer_load_dword v22, v9, s[8:11], s57 offen
    buffer_load_dword v23, v9, s[8:11], s57 offen offset:128
    s_add_u32 s57, s57, 28672
    buffer_load_dword v24, v9, s[8:11], s57 offen
    buffer_load_dword v25, v9, s[8:11], s57 offen offset:128
    s_add_u32 s57, s57, 28672
    buffer_load_dword v26, v9, s[8:11], s57 offen
    buffer_load_dword v27, v9, s[8:11], s57 offen offset:128
    s_add_u32 s57, s57, 28672
    buffer_load_dword v28, v9, s[8:11], s57 offen
    buffer_load_dword v29, v9, s[8:11], s57 offen offset:128
    s_add_u32 s57, s57, 28672
    buffer_load_dword v30, v9, s[8:11], s57 offen
    buffer_load_dword v31, v9, s[8:11], s57 offen offset:128
    s_mov_b64 exec, -1
    s_call_b64 s[30:31], ffn_kernel_dma3
    s_call_b64 s[30:31], ffn_kernel_dma3
    s_call_b64 s[30:31], ffn_kernel_dma3
    v_mov_b32 v39, 0
    v_mov_b32 v40, 0
    v_mov_b32 v41, 0
    v_mov_b32 v42, 0
    v_mov_b32 v43, 0
    s_mul_i32 s23, s51, 6144
    s_add_u32 s23, s23, 7168
    s_waitcnt vmcnt(18)
    v_add_f32 v16, v16, v18
    v_add_f32 v17, v17, v19
    v_add_f32 v16, v16, v20
    v_add_f32 v17, v17, v21
    v_add_f32 v16, v16, v22
    v_add_f32 v17, v17, v23
    v_add_f32 v16, v16, v24
    v_add_f32 v17, v17, v25
    v_add_f32 v16, v16, v26
    v_add_f32 v17, v17, v27
    v_add_f32 v16, v16, v28
    v_add_f32 v17, v17, v29
    v_add_f32 v16, v16, v30
    v_add_f32 v17, v17, v31
    v_cvt_pk_bf16_f32 v36, v16, v17
    v_lshlrev_b32 v18, 16, v36
    v_and_b32 v19, 0xffff0000, v36
    v_sub_f32 v16, v16, v18
    v_sub_f32 v17, v17, v19
    v_cvt_pk_bf16_f32 v37, v16, v17
    v_lshlrev_b32 v18, 16, v37
    v_and_b32 v19, 0xffff0000, v37
    v_sub_f32 v16, v16, v18
    v_sub_f32 v17, v17, v19
    v_cvt_pk_bf16_f32 v38, v16, v17
    v_cmp_gt_u32 vcc, 480, v0
    s_nop 0
    s_mov_b64 exec, vcc
    ds_write_b128 v11, v[36:39] offset:0
    ds_write_b128 v11, v[40:43] offset:512
    s_mov_b64 exec, -1
    s_waitcnt vmcnt(34)
    s_barrier
    s_call_b64 s[30:31], ffn_kernel_dma3
    s_lshl_b32 s5, s49, 11
    s_add_u32 s5, s5, s69
    buffer_load_dwordx4 v[64:67], v3, s[8:11], s5 offen
    buffer_load_dwordx4 v[68:71], v3, s[8:11], s5 offen offset:1024
    s_waitcnt vmcnt(20)
    s_barrier
    s_call_b64 s[30:31], ffn_kernel_dma3
    s_waitcnt vmcnt(20)
    s_barrier
    s_call_b64 s[30:31], ffn_kernel_dma3
    s_waitcnt vmcnt(12)
    v_lshlrev_b32 v56, 16, v64
    v_and_b32 v57, 0xffff0000, v64
    v_lshlrev_b32 v58, 16, v68
    v_and_b32 v59, 0xffff0000, v68
    v_add_f32 v72, v56, v57
    v_mul_f32 v76, v56, v56
    v_add_f32 v60, v58, v59
    v_fmac_f32 v76, v57, v57
    v_add_f32 v72, v72, v60
    v_fmac_f32 v76, v58, v58
    v_fmac_f32 v76, v59, v59
    v_lshlrev_b32 v56, 16, v65
    v_and_b32 v57, 0xffff0000, v65
    v_lshlrev_b32 v58, 16, v69
    v_and_b32 v59, 0xffff0000, v69
    v_add_f32 v73, v56, v57
    v_mul_f32 v77, v56, v56
    v_add_f32 v60, v58, v59
    v_fmac_f32 v77, v57, v57
    v_add_f32 v73, v73, v60
    v_fmac_f32 v77, v58, v58
    v_fmac_f32 v77, v59, v59
    s_waitcnt vmcnt(20)
    s_barrier
    s_call_b64 s[30:31], ffn_kernel_dma3
    s_waitcnt vmcnt(18)
    v_lshlrev_b32 v56, 16, v66
    v_and_b32 v57, 0xffff0000, v66
    v_lshlrev_b32 v58, 16, v70
    v_and_b32 v59, 0xffff0000, v70
    v_add_f32 v74, v56, v57
    v_mul_f32 v78, v56, v56
    v_add_f32 v60, v58, v59
    v_fmac_f32 v78, v57, v57
    v_add_f32 v74, v74, v60
    v_fmac_f32 v78, v58, v58
    v_fmac_f32 v78, v59, v59
    v_lshlrev_b32 v56, 16, v67
    v_and_b32 v57, 0xffff0000, v67
    v_lshlrev_b32 v58, 16, v71
    v_and_b32 v59, 0xffff0000, v71
    v_add_f32 v75, v56, v57
    v_mul_f32 v79, v56, v56
    v_add_f32 v60, v58, v59
    v_fmac_f32 v79, v57, v57
    v_add_f32 v75, v75, v60
    v_fmac_f32 v79, v58, v58
    v_fmac_f32 v79, v59, v59
    s_waitcnt vmcnt(20)
    s_barrier
    s_call_b64 s[30:31], ffn_kernel_dma3
    v_permlane32_swap_b32 v72, v74
    v_permlane32_swap_b32 v73, v75
    v_permlane32_swap_b32 v76, v78
    v_permlane32_swap_b32 v77, v79
    v_add_f32 v72, v72, v74
    v_add_f32 v73, v73, v75
    v_add_f32 v76, v76, v78
    v_add_f32 v77, v77, v79
    v_permlane16_swap_b32 v72, v73
    s_nop 0
    v_permlane16_swap_b32 v76, v77
    v_add_f32 v72, v72, v73
    v_add_f32 v73, v76, v77
    s_nop 0
    v_add_f32_dpp v74, v72, v72 row_ror:8 row_mask:0xf bank_mask:0xf
    v_add_f32_dpp v75, v73, v73 row_ror:8 row_mask:0xf bank_mask:0xf
    s_waitcnt vmcnt(18)
    s_barrier
    s_call_b64 s[30:31], ffn_kernel_dma3
    v_or_b32 v75, 0x80000000, v75
    v_and_b32 v12, 7, v1
    v_lshlrev_b32 v12, 2, v12
    v_lshrrev_b32 v13, 4, v1
    v_add_u32 v12, v12, v13
    v_lshlrev_b32 v12, 3, v12
    s_lshl_b32 s5, s48, 4
    s_add_u32 s5, s5, s49
    s_lshl_b32 s5, s5, 10
    s_lshl_b32 s6, s51, 8
    s_add_u32 s5, s5, s6
    s_add_u32 s5, s5, 0x60000
    buffer_store_dwordx2 v[74:75], v12, s[8:11], s5 offen sc1
    s_waitcnt vmcnt(19)
    s_barrier
    s_call_b64 s[30:31], ffn_kernel_dma3
    s_waitcnt vmcnt(19)
    s_barrier
    s_call_b64 s[30:31], ffn_kernel_dma3
    v_lshlrev_b32 v12, 4, v7
    v_add_u32 v12, ffn_tail-ffn_kernel-4, v12
    v_min_u32 v13, code_end-ffn_kernel-32, v12
    global_load_dwordx4 v[88:91], v13, s[28:29]
    v_add_u32 v12, 4096, v12
    v_min_u32 v13, code_end-ffn_kernel-32, v12
    global_load_dwordx4 v[88:91], v13, s[28:29]
    v_add_u32 v12, 4096, v12
    v_min_u32 v13, code_end-ffn_kernel-32, v12
    global_load_dwordx4 v[88:91], v13, s[28:29]
    s_waitcnt vmcnt(22)
    s_barrier
    s_call_b64 s[30:31], ffn_kernel_dma3
    s_waitcnt vmcnt(22)
    s_barrier
    s_call_b64 s[30:31], ffn_kernel_dma3
    s_lshl_b32 s5, s48, 14
    s_lshl_b32 s6, s51, 8
    s_add_u32 s5, s5, s6
    s_add_u32 s5, s5, 0x60000
    s_add_u32 s6, s5, 4096
    v_lshlrev_b32 v12, 13, v4
    v_lshl_add_u32 v12, v5, 3, v12
    buffer_load_dwordx2 v[72:73], v12, s[8:11], s5 offen offset:0 sc1
    buffer_load_dwordx2 v[74:75], v12, s[8:11], s5 offen offset:1024 sc1
    buffer_load_dwordx2 v[76:77], v12, s[8:11], s5 offen offset:2048 sc1
    s_waitcnt vmcnt(24)
    s_barrier
    s_call_b64 s[30:31], ffn_kernel_dma3
    buffer_load_dwordx2 v[78:79], v12, s[8:11], s5 offen offset:3072 sc1
    buffer_load_dwordx2 v[80:81], v12, s[8:11], s6 offen offset:0 sc1
    buffer_load_dwordx2 v[82:83], v12, s[8:11], s6 offen offset:1024 sc1
    s_waitcnt vmcnt(27)
    s_barrier
    s_call_b64 s[30:31], ffn_kernel_dma3
    buffer_load_dwordx2 v[84:85], v12, s[8:11], s6 offen offset:2048 sc1
    buffer_load_dwordx2 v[86:87], v12, s[8:11], s6 offen offset:3072 sc1
    s_waitcnt vmcnt(26)
    s_barrier
    s_call_b64 s[30:31], ffn_kernel_dma24
    s_waitcnt vmcnt(26)
    s_barrier
    s_call_b64 s[30:31], ffn_kernel_dma24
    s_waitcnt vmcnt(12)
    s_mov_b32 s60, 0
ffn_kernel_retry8:
    v_and_b32 v13, v73, v75
    v_and_b32 v14, v77, v79
    v_and_b32 v15, v81, v83
    v_and_b32 v13, v13, v85
    v_and_b32 v14, v14, v87
    v_and_b32 v13, v13, v14
    v_and_b32 v13, v13, v15
    v_cmp_le_i32 vcc, 0, v13
    s_add_u32 s60, s60, 1
    s_cmp_eq_u64 vcc, 0
    s_cbranch_scc1 ffn_kernel_ok9
    s_cmp_gt_u32 s60, 0x40000
    s_cbranch_scc1 ffn_kernel_ok9
    buffer_load_dwordx2 v[72:73], v12, s[8:11], s5 offen offset:0 sc1
    buffer_load_dwordx2 v[74:75], v12, s[8:11], s5 offen offset:1024 sc1
    buffer_load_dwordx2 v[76:77], v12, s[8:11], s5 offen offset:2048 sc1
    buffer_load_dwordx2 v[78:79], v12, s[8:11], s5 offen offset:3072 sc1
    buffer_load_dwordx2 v[80:81], v12, s[8:11], s6 offen offset:0 sc1
    buffer_load_dwordx2 v[82:83], v12, s[8:11], s6 offen offset:1024 sc1
    buffer_load_dwordx2 v[84:85], v12, s[8:11], s6 offen offset:2048 sc1
    buffer_load_dwordx2 v[86:87], v12, s[8:11], s6 offen offset:3072 sc1
    s_waitcnt vmcnt(0)
    s_branch ffn_kernel_retry8
ffn_kernel_ok9:
    s_waitcnt vmcnt(23)
    s_barrier
    s_call_b64 s[30:31], ffn_kernel_dma24
    v_add_f32 v72, v72, v74
    v_add_f32 v73, v73, v75
    v_add_f32 v72, v72, v76
    v_add_f32 v73, v73, v77
    v_add_f32 v72, v72, v78
    v_add_f32 v73, v73, v79
    v_add_f32 v72, v72, v80
    v_add_f32 v73, v73, v81
    v_add_f32 v72, v72, v82
    v_add_f32 v73, v73, v83
    v_add_f32 v72, v72, v84
    v_add_f32 v73, v73, v85
    v_add_f32 v72, v72, v86
    v_add_f32 v73, v73, v87
    v_mov_b32 v74, v72
    v_mov_b32 v75, v73
    s_nop 0
    v_permlane32_swap_b32 v72, v74
    v_permlane32_swap_b32 v73, v75
    s_waitcnt vmcnt(20)
    s_barrier
    s_call_b64 s[30:31], ffn_kernel_dma24
    s_lshl_b32 s5, s51, 8
    s_add_u32 s5, s5, 154624
    v_lshl_add_u32 v13, v5, 3, s5
    v_add_f32 v8, v72, v74
    v_add_f32 v14, v73, v75
    v_mul_f32 v8, 0.001953125, v8
    v_mul_f32 v14, -0.001953125, v14
    v_fma_f32 v14, -v8, v8, v14
    v_max_f32 v14, 0, v14
    v_cvt_pk_bf16_f32 v14, v14, v14
    v_and_b32 v14, 0xffff0000, v14
    v_add_f32 v14, 0x3727c5ac, v14
    v_cvt_pk_bf16_f32 v14, v14, v14
    v_and_b32 v14, 0xffff0000, v14
    v_sqrt_f32 v14, v14
    s_nop 0
    v_cvt_pk_bf16_f32 v15, v14, v14
    v_and_b32 v15, 0xffff0000, v15
    v_cvt_pk_bf16_f32 v14, v8, v8
    v_and_b32 v14, 0xffff0000, v14
    ds_write_b64 v13, v[14:15] offset:2048
    s_waitcnt lgkmcnt(0)
    s_barrier
    s_call_b64 s[30:31], ffn_kernel_dma24
    s_barrier
    s_call_b64 s[30:31], ffn_kernel_dma24
    s_waitcnt vmcnt(0)
    s_barrier
    s_cmp_lg_u32 s51, 0
    s_cbranch_scc1 ffn_kernel_go6
    s_lshl_b32 s5, s16, 7
    s_add_u32 s5, s5, 0x1d000
    v_lshlrev_b32 v10, 2, v5
    s_mov_b32 s60, 0
ffn_kernel_poll5:
    buffer_load_dword v11, v10, s[8:11], s5 offen sc1
    s_add_u32 s60, s60, 1
    s_waitcnt vmcnt(0)
    v_cmp_eq_u32 vcc, 1, v11
    s_cmp_gt_u32 s60, 0x40000
    s_cbranch_scc1 ffn_kernel_go6
    s_cmp_lg_u64 vcc, -1
    s_cbranch_scc1 ffn_kernel_poll5
ffn_kernel_go6:
    s_barrier
    s_endpgm
ffn_kernel_dma24:
    s_add_u32 m0, s23, s64
    s_nop 0
    buffer_load_dwordx4 v3, s[8:11], s24 offen offset:0 lds
    buffer_load_dwordx4 v3, s[8:11], s24 offen offset:1024 lds
    buffer_load_dwordx4 v3, s[8:11], s24 offen offset:2048 lds
    s_add_u32 s59, s23, 3072
    s_add_u32 m0, s59, s64
    s_add_u32 s24, s24, 3072
    buffer_load_dwordx4 v3, s[8:11], s25 offen offset:0 lds
    buffer_load_dwordx4 v3, s[8:11], s25 offen offset:1024 lds
    buffer_load_dwordx4 v3, s[8:11], s25 offen offset:2048 lds
    s_add_u32 s25, s25, 3072
    s_add_u32 s64, s64, 24576
    s_cmp_eq_u32 s64, 147456
    s_cselect_b32 s64, 0, s64
    s_setpc_b64 s[30:31]
ffn_kernel_H2_M:
    v_lshlrev_b32 v60, 4, v0
    global_load_dwordx4 v[56:59], v60, s[28:29]
    global_load_dwordx4 v[56:59], v60, s[28:29] offset:4080
    s_lshl_b32 s52, s48, 2
    s_add_u32 s52, s52, s51
    s_mov_b32 s62, 0x3f803f80
    s_mul_i32 s57, s52, 112
    s_mul_i32 s58, s49, 7
    s_add_u32 s57, s57, s58
    s_lshl_b32 s57, s57, 10
    s_add_u32 s57, s57, 0xcc0000
    v_lshlrev_b32 v6, 9, v4
    v_lshl_add_u32 v6, v5, 2, v6
    s_lshl_b32 s5, s51, 11
    s_add_u32 s5, s5, 16384
    v_add_u32 v6, s5, v6
    v_add_u32 v12, 7168, v3
    v_add_u32 v13, 31744, v3
    v_add_u32 v10, 7168, v6
    v_add_u32 v11, 31744, v6
    s_mov_b32 s63, 56320
    v_mov_b32 v8, 0
    v_mov_b32 v9, 0
    v_mov_b32 v14, 0
    v_mov_b32 v15, 0
    v_mov_b32 v60, 0
    v_mov_b32 v61, 0
    v_mov_b32 v62, 0
    v_mov_b32 v63, 0
    v_mov_b32 v64, 0
    v_mov_b32 v65, 0
    v_mov_b32 v66, 0
    v_mov_b32 v67, 0
    v_mov_b32 v68, 0
    v_mov_b32 v69, 0
    v_mov_b32 v70, 0
    v_mov_b32 v71, 0
    v_mov_b32 v72, 0
    v_mov_b32 v73, 0
    v_mov_b32 v74, 0
    v_mov_b32 v75, 0
    v_mov_b32 v76, 0
    v_mov_b32 v77, 0
    v_mov_b32 v78, 0
    v_mov_b32 v79, 0
    v_mov_b32 v80, 0
    v_mov_b32 v81, 0
    v_mov_b32 v82, 0
    v_mov_b32 v83, 0
    v_mov_b32 v84, 0
    v_mov_b32 v85, 0
    v_mov_b32 v86, 0
    v_mov_b32 v87, 0
    v_mov_b32 v88, 0
    v_mov_b32 v89, 0
    v_mov_b32 v90, 0
    v_mov_b32 v91, 0
    v_mov_b32 v92, 0
    v_mov_b32 v93, 0
    v_mov_b32 v94, 0
    v_mov_b32 v95, 0
    v_mov_b32 v96, 0
    v_mov_b32 v97, 0
    v_mov_b32 v98, 0
    v_mov_b32 v99, 0
    v_mov_b32 v100, 0
    v_mov_b32 v101, 0
    v_mov_b32 v102, 0
    v_mov_b32 v103, 0
    v_mov_b32 v104, 0
    v_mov_b32 v105, 0
    v_mov_b32 v106, 0
    v_mov_b32 v107, 0
    v_mov_b32 v108, 0
    v_mov_b32 v109, 0
    v_mov_b32 v110, 0
    v_mov_b32 v111, 0
    v_mov_b32 v112, 0
    v_mov_b32 v113, 0
    v_mov_b32 v114, 0
    v_mov_b32 v115, 0
    v_mov_b32 v116, 0
    v_mov_b32 v117, 0
    v_mov_b32 v118, 0
    v_mov_b32 v119, 0
    v_mov_b32 v120, 0
    v_mov_b32 v121, 0
    v_mov_b32 v122, 0
    v_mov_b32 v123, 0
    v_mov_b32 v124, 0
    v_mov_b32 v125, 0
    v_mov_b32 v126, 0
    v_mov_b32 v127, 0
    v_mov_b32 v128, 0
    v_mov_b32 v129, 0
    v_mov_b32 v130, 0
    v_mov_b32 v131, 0
    v_mov_b32 v132, 0
    v_mov_b32 v133, 0
    v_mov_b32 v134, 0
    v_mov_b32 v135, 0
    v_mov_b32 v136, 0
    v_mov_b32 v137, 0
    v_mov_b32 v138, 0
    v_mov_b32 v139, 0
    v_mov_b32 v140, 0
    v_mov_b32 v141, 0
    v_mov_b32 v142, 0
    v_mov_b32 v143, 0
    v_mov_b32 v144, 0
    v_mov_b32 v145, 0
    v_mov_b32 v146, 0
    v_mov_b32 v147, 0
    v_mov_b32 v148, 0
    v_mov_b32 v149, 0
    v_mov_b32 v150, 0
    v_mov_b32 v151, 0
    v_mov_b32 v152, 0
    v_mov_b32 v153, 0
    v_mov_b32 v154, 0
    v_mov_b32 v155, 0
    v_mov_b32 v156, 0
    v_mov_b32 v157, 0
    v_mov_b32 v158, 0
    v_mov_b32 v159, 0
    v_mov_b32 v160, 0
    v_mov_b32 v161, 0
    v_mov_b32 v162, 0
    v_mov_b32 v163, 0
    v_mov_b32 v164, 0
    v_mov_b32 v165, 0
    v_mov_b32 v166, 0
    v_mov_b32 v167, 0
    v_mov_b32 v168, 0
    v_mov_b32 v169, 0
    v_mov_b32 v170, 0
    v_mov_b32 v171, 0
    v_mov_b32 v172, 0
    v_mov_b32 v173, 0
    v_mov_b32 v174, 0
    v_mov_b32 v175, 0
    s_waitcnt lgkmcnt(0)
    s_mov_b32 s8, s46
    s_mov_b32 s9, s47
    s_mov_b32 s10, 0x15c0000
    s_mov_b32 s11, 0x20000
    s_mov_b32 s66, 0
    s_barrier
    v_add_u32 v16, 1024, v10
    ds_read_b128 a[0:3], v12 offset:0
    ds_read_b128 a[4:7], v12 offset:1024
    ds_read_b128 a[8:11], v12 offset:2048
    ds_read_b128 a[12:15], v12 offset:3072
    ds_read2_b32 v[48:49], v10 offset0:0 offset1:32
    ds_read2_b32 v[50:51], v10 offset0:64 offset1:96
    ds_read_b128 a[16:19], v12 offset:4096
    ds_read_b128 a[20:23], v12 offset:5120
    ds_read_b128 a[24:27], v12 offset:6144
    ds_read_b128 a[28:31], v12 offset:7168
    ds_read_b128 a[32:35], v12 offset:8192
    ds_read_b128 a[36:39], v12 offset:9216
ffn_kernel_loop10:
    ds_read2_b32 v[52:53], v16 offset0:0 offset1:32
    ds_read2_b32 v[54:55], v16 offset0:64 offset1:96
    ds_read_b128 a[40:43], v12 offset:10240
    ds_read_b128 a[44:47], v12 offset:11264
    s_waitcnt lgkmcnt(10)
    v_mfma_f32_32x32x16_bf16 v[64:79], a[0:3], v[48:51], v[64:79]
    v_mfma_f32_32x32x16_bf16 v[80:95], a[4:7], v[48:51], v[80:95]
    s_barrier
    ds_read_b128 a[48:51], v12 offset:12288
    ds_read_b128 a[52:55], v12 offset:13312
    v_mfma_f32_32x32x16_bf16 v[96:111], a[8:11], v[48:51], v[96:111]
    v_mfma_f32_32x32x16_bf16 v[112:127], a[12:15], v[48:51], v[112:127]
    ds_read_b128 a[0:3], v13 offset:0
    ds_read_b128 a[4:7], v13 offset:1024
    s_waitcnt lgkmcnt(12)
    v_mfma_f32_32x32x16_bf16 v[128:143], a[16:19], v[48:51], v[128:143]
    v_mfma_f32_32x32x16_bf16 v[144:159], a[20:23], v[48:51], v[144:159]
    ds_read_b128 a[8:11], v13 offset:2048
    ds_read_b128 a[12:15], v13 offset:3072
    s_waitcnt lgkmcnt(12)
    v_mfma_f32_32x32x16_bf16 v[160:175], a[24:27], v[48:51], v[160:175]
    ds_read2_b32 v[48:49], v11 offset0:0 offset1:32
    ds_read2_b32 v[50:51], v11 offset0:64 offset1:96
    s_waitcnt lgkmcnt(10)
    v_mfma_f32_32x32x16_bf16 v[64:79], a[28:31], v[52:55], v[64:79]
    ds_read_b128 a[16:19], v13 offset:4096
    ds_read_b128 a[20:23], v13 offset:5120
    v_mfma_f32_32x32x16_bf16 v[80:95], a[32:35], v[52:55], v[80:95]
    v_mfma_f32_32x32x16_bf16 v[96:111], a[36:39], v[52:55], v[96:111]
    ds_read_b128 a[24:27], v13 offset:6144
    ds_read_b128 a[28:31], v13 offset:7168
    s_waitcnt lgkmcnt(12)
    v_mfma_f32_32x32x16_bf16 v[112:127], a[40:43], v[52:55], v[112:127]
    v_mfma_f32_32x32x16_bf16 v[128:143], a[44:47], v[52:55], v[128:143]
    ds_read_b128 a[32:35], v13 offset:8192
    ds_read_b128 a[36:39], v13 offset:9216
    s_waitcnt lgkmcnt(12)
    v_mfma_f32_32x32x16_bf16 v[144:159], a[48:51], v[52:55], v[144:159]
    v_mov_b32 v12, v13
    v_mov_b32 v10, v11
    v_add_u32 v16, 1024, v11
    v_add_u32 v13, s63, v3
    v_add_u32 v11, s63, v6
    s_add_u32 s63, s63, 24576
    s_cmp_eq_u32 s63, 154624
    s_cselect_b32 s63, 7168, s63
    v_mfma_f32_32x32x16_bf16 v[160:175], a[52:55], v[52:55], v[160:175]
    s_add_u32 s66, s66, 1
    s_cmp_lt_u32 s66, 15
    s_cbranch_scc1 ffn_kernel_loop10
    ds_read2_b32 v[52:53], v16 offset0:0 offset1:32
    ds_read2_b32 v[54:55], v16 offset0:64 offset1:96
    ds_read_b128 a[40:43], v12 offset:10240
    ds_read_b128 a[44:47], v12 offset:11264
    s_waitcnt lgkmcnt(10)
    v_mfma_f32_32x32x16_bf16 v[64:79], a[0:3], v[48:51], v[64:79]
    v_mfma_f32_32x32x16_bf16 v[80:95], a[4:7], v[48:51], v[80:95]
    s_barrier
    ds_read_b128 a[48:51], v12 offset:12288
    ds_read_b128 a[52:55], v12 offset:13312
    v_mfma_f32_32x32x16_bf16 v[96:111], a[8:11], v[48:51], v[96:111]
    s_lshl_b32 s5, s51, 8
    s_add_u32 s5, s5, 156672
    v_lshl_add_u32 v8, v5, 3, s5
    ds_read_b64 v[8:9], v8
    v_mfma_f32_32x32x16_bf16 v[112:127], a[12:15], v[48:51], v[112:127]
    s_waitcnt lgkmcnt(11)
    v_mfma_f32_32x32x16_bf16 v[128:143], a[16:19], v[48:51], v[128:143]
    ds_read_b128 a[0:3], v3 offset:0
    v_mfma_f32_32x32x16_bf16 v[144:159], a[20:23], v[48:51], v[144:159]
    ds_read_b128 a[4:7], v3 offset:1024
    s_waitcnt lgkmcnt(11)
    v_mfma_f32_32x32x16_bf16 v[160:175], a[24:27], v[48:51], v[160:175]
    ds_read_b128 a[8:11], v3 offset:2048
    s_waitcnt lgkmcnt(8)
    v_mfma_f32_32x32x16_bf16 v[64:79], a[28:31], v[52:55], v[64:79]
    ds_read_b128 a[12:15], v3 offset:3072
    s_waitcnt lgkmcnt(4)
    v_cvt_pk_bf16_f32 v20, -v8, v9
    v_rcp_f32 v15, v9
    v_mul_f32 v26, v9, v9
    v_mfma_f32_32x32x16_bf16 v[80:95], a[32:35], v[52:55], v[80:95]
    ds_read_b128 a[16:19], v3 offset:4096
    v_mov_b32 v21, v20
    v_mov_b32 v22, v20
    v_mov_b32 v23, 0
    v_mfma_f32_32x32x16_bf16 v[96:111], a[36:39], v[52:55], v[96:111]
    ds_read_b128 a[20:23], v3 offset:5120
    v_mul_f32 v24, 0xc0135761, v15
    v_mul_f32 v25, v15, v15
    v_mul_f32 v25, v25, v15
    v_mfma_f32_32x32x16_bf16 v[112:127], a[40:43], v[52:55], v[112:127]
    ds_read_b128 a[24:27], v3 offset:6144
    v_mul_f32 v25, 0xbdd2d3e8, v25
    v_mov_b32 v27, v26
    v_mfma_f32_32x32x16_bf16 v[128:143], a[44:47], v[52:55], v[128:143]
    v_mfma_f32_32x32x16_bf16 v[144:159], a[48:51], v[52:55], v[144:159]
ffn_tail:
    s_barrier
    v_mfma_f32_32x32x16_bf16 v[160:175], a[52:55], v[52:55], v[160:175]
    s_waitcnt lgkmcnt(0)
    v_mfma_f32_32x32x16_bf16 v[64:79], a[0:3], v[20:23], v[64:79]
    v_mfma_f32_32x32x16_bf16 v[80:95], a[4:7], v[20:23], v[80:95]
    v_mfma_f32_32x32x16_bf16 v[96:111], a[8:11], v[20:23], v[96:111]
    v_mfma_f32_32x32x16_bf16 v[112:127], a[12:15], v[20:23], v[112:127]
    v_mfma_f32_32x32x16_bf16 v[128:143], a[16:19], v[20:23], v[128:143]
    v_mfma_f32_32x32x16_bf16 v[144:159], a[20:23], v[20:23], v[144:159]
    v_mfma_f32_32x32x16_bf16 v[160:175], a[24:27], v[20:23], v[160:175]
    s_nop 5
    v_pk_mul_f32 v[28:29], v[64:65], v[64:65]
    v_pk_mul_f32 v[30:31], v[66:67], v[66:67]
    v_pk_mul_f32 v[32:33], v[68:69], v[68:69]
    v_pk_mul_f32 v[34:35], v[70:71], v[70:71]
    v_pk_fma_f32 v[28:29], v[28:29], v[24:25], v[24:25] op_sel:[0,1,0] op_sel_hi:[1,1,0]
    v_pk_fma_f32 v[30:31], v[30:31], v[24:25], v[24:25] op_sel:[0,1,0] op_sel_hi:[1,1,0]
    v_pk_fma_f32 v[32:33], v[32:33], v[24:25], v[24:25] op_sel:[0,1,0] op_sel_hi:[1,1,0]
    v_pk_fma_f32 v[34:35], v[34:35], v[24:25], v[24:25] op_sel:[0,1,0] op_sel_hi:[1,1,0]
    v_pk_mul_f32 v[28:29], v[28:29], v[64:65]
    v_pk_mul_f32 v[30:31], v[30:31], v[66:67]
    v_pk_mul_f32 v[32:33], v[32:33], v[68:69]
    v_pk_mul_f32 v[34:35], v[34:35], v[70:71]
    v_exp_f32 v28, v28
    v_exp_f32 v30, v30
    v_exp_f32 v32, v32
    v_exp_f32 v34, v34
    v_exp_f32 v29, v29
    v_exp_f32 v31, v31
    v_pk_mul_f32 v[36:37], v[64:65], v[72:73]
    v_pk_fma_f32 v[28:29], v[28:29], v[26:27], v[26:27]
    v_pk_mul_f32 v[38:39], v[66:67], v[74:75]
    v_exp_f32 v33, v33
    v_exp_f32 v35, v35
    v_rcp_f32 v28, v28
    v_pk_mul_f32 v[40:41], v[68:69], v[76:77]
    v_pk_mul_f32 v[42:43], v[70:71], v[78:79]
    v_rcp_f32 v29, v29
    s_nop 0
    v_pk_mul_f32 v[36:37], v[36:37], v[28:29]
    v_pk_fma_f32 v[30:31], v[30:31], v[26:27], v[26:27]
    v_pk_fma_f32 v[32:33], v[32:33], v[26:27], v[26:27]
    v_pk_fma_f32 v[34:35], v[34:35], v[26:27], v[26:27]
    v_cvt_pk_bf16_f32 v44, v36, v37
    v_rcp_f32 v30, v30
    v_rcp_f32 v32, v32
    v_rcp_f32 v34, v34
    v_rcp_f32 v31, v31
    v_rcp_f32 v33, v33
    v_rcp_f32 v35, v35
    v_pk_mul_f32 v[38:39], v[38:39], v[30:31]
    v_pk_mul_f32 v[40:41], v[40:41], v[32:33]
    v_pk_mul_f32 v[42:43], v[42:43], v[34:35]
    v_cvt_pk_bf16_f32 v45, v38, v39
    v_cvt_pk_bf16_f32 v46, v40, v41
    v_cvt_pk_bf16_f32 v47, v42, v43
    buffer_store_dwordx4 v[44:47], v3, s[8:11], s57 offen offset:0 sc1
    v_pk_mul_f32 v[28:29], v[80:81], v[80:81]
    v_pk_mul_f32 v[30:31], v[82:83], v[82:83]
    v_pk_mul_f32 v[32:33], v[84:85], v[84:85]
    v_pk_mul_f32 v[34:35], v[86:87], v[86:87]
    v_pk_fma_f32 v[28:29], v[28:29], v[24:25], v[24:25] op_sel:[0,1,0] op_sel_hi:[1,1,0]
    v_pk_fma_f32 v[30:31], v[30:31], v[24:25], v[24:25] op_sel:[0,1,0] op_sel_hi:[1,1,0]
    v_pk_fma_f32 v[32:33], v[32:33], v[24:25], v[24:25] op_sel:[0,1,0] op_sel_hi:[1,1,0]
    v_pk_fma_f32 v[34:35], v[34:35], v[24:25], v[24:25] op_sel:[0,1,0] op_sel_hi:[1,1,0]
    v_pk_mul_f32 v[28:29], v[28:29], v[80:81]
    v_pk_mul_f32 v[30:31], v[30:31], v[82:83]
    v_pk_mul_f32 v[32:33], v[32:33], v[84:85]
    v_pk_mul_f32 v[34:35], v[34:35], v[86:87]
    v_exp_f32 v28, v28
    v_exp_f32 v30, v30
    v_exp_f32 v32, v32
    v_exp_f32 v34, v34
    v_exp_f32 v29, v29
    v_exp_f32 v31, v31
    v_pk_mul_f32 v[36:37], v[80:81], v[88:89]
    v_pk_fma_f32 v[28:29], v[28:29], v[26:27], v[26:27]
    v_pk_mul_f32 v[38:39], v[82:83], v[90:91]
    v_exp_f32 v33, v33
    v_exp_f32 v35, v35
    v_rcp_f32 v28, v28
    v_pk_mul_f32 v[40:41], v[84:85], v[92:93]
    v_pk_mul_f32 v[42:43], v[86:87], v[94:95]
    v_rcp_f32 v29, v29
    s_nop 0
    v_pk_mul_f32 v[36:37], v[36:37], v[28:29]
    v_pk_fma_f32 v[30:31], v[30:31], v[26:27], v[26:27]
    v_pk_fma_f32 v[32:33], v[32:33], v[26:27], v[26:27]
    v_pk_fma_f32 v[34:35], v[34:35], v[26:27], v[26:27]
    v_cvt_pk_bf16_f32 v16, v36, v37
    v_rcp_f32 v30, v30
    v_rcp_f32 v32, v32
    v_rcp_f32 v34, v34
    v_rcp_f32 v31, v31
    v_rcp_f32 v33, v33
    v_rcp_f32 v35, v35
    v_pk_mul_f32 v[38:39], v[38:39], v[30:31]
    v_pk_mul_f32 v[40:41], v[40:41], v[32:33]
    v_pk_mul_f32 v[42:43], v[42:43], v[34:35]
    v_cvt_pk_bf16_f32 v17, v38, v39
    v_cvt_pk_bf16_f32 v18, v40, v41
    v_cvt_pk_bf16_f32 v19, v42, v43
    buffer_store_dwordx4 v[16:19], v3, s[8:11], s57 offen offset:1024 sc1
    v_pk_mul_f32 v[28:29], v[96:97], v[96:97]
    v_pk_mul_f32 v[30:31], v[98:99], v[98:99]
    v_pk_mul_f32 v[32:33], v[100:101], v[100:101]
    v_pk_mul_f32 v[34:35], v[102:103], v[102:103]
    v_pk_fma_f32 v[28:29], v[28:29], v[24:25], v[24:25] op_sel:[0,1,0] op_sel_hi:[1,1,0]
    v_pk_fma_f32 v[30:31], v[30:31], v[24:25], v[24:25] op_sel:[0,1,0] op_sel_hi:[1,1,0]
    v_pk_fma_f32 v[32:33], v[32:33], v[24:25], v[24:25] op_sel:[0,1,0] op_sel_hi:[1,1,0]
    v_pk_fma_f32 v[34:35], v[34:35], v[24:25], v[24:25] op_sel:[0,1,0] op_sel_hi:[1,1,0]
    v_pk_mul_f32 v[28:29], v[28:29], v[96:97]
    v_pk_mul_f32 v[30:31], v[30:31], v[98:99]
    v_pk_mul_f32 v[32:33], v[32:33], v[100:101]
    v_pk_mul_f32 v[34:35], v[34:35], v[102:103]
    v_exp_f32 v28, v28
    v_exp_f32 v30, v30
    v_exp_f32 v32, v32
    v_exp_f32 v34, v34
    v_exp_f32 v29, v29
    v_exp_f32 v31, v31
    v_pk_mul_f32 v[36:37], v[96:97], v[104:105]
    v_pk_fma_f32 v[28:29], v[28:29], v[26:27], v[26:27]
    v_pk_mul_f32 v[38:39], v[98:99], v[106:107]
    v_exp_f32 v33, v33
    v_exp_f32 v35, v35
    v_rcp_f32 v28, v28
    v_pk_mul_f32 v[40:41], v[100:101], v[108:109]
    v_pk_mul_f32 v[42:43], v[102:103], v[110:111]
    v_rcp_f32 v29, v29
    s_nop 0
    v_pk_mul_f32 v[36:37], v[36:37], v[28:29]
    v_pk_fma_f32 v[30:31], v[30:31], v[26:27], v[26:27]
    v_pk_fma_f32 v[32:33], v[32:33], v[26:27], v[26:27]
    v_pk_fma_f32 v[34:35], v[34:35], v[26:27], v[26:27]
    v_cvt_pk_bf16_f32 v44, v36, v37
    v_rcp_f32 v30, v30
    v_rcp_f32 v32, v32
    v_rcp_f32 v34, v34
    v_rcp_f32 v31, v31
    v_rcp_f32 v33, v33
    v_rcp_f32 v35, v35
    v_pk_mul_f32 v[38:39], v[38:39], v[30:31]
    v_pk_mul_f32 v[40:41], v[40:41], v[32:33]
    v_pk_mul_f32 v[42:43], v[42:43], v[34:35]
    v_cvt_pk_bf16_f32 v45, v38, v39
    v_cvt_pk_bf16_f32 v46, v40, v41
    v_cvt_pk_bf16_f32 v47, v42, v43
    buffer_store_dwordx4 v[44:47], v3, s[8:11], s57 offen offset:2048 sc1
    v_pk_mul_f32 v[28:29], v[112:113], v[112:113]
    v_pk_mul_f32 v[30:31], v[114:115], v[114:115]
    v_pk_mul_f32 v[32:33], v[116:117], v[116:117]
    v_pk_mul_f32 v[34:35], v[118:119], v[118:119]
    v_pk_fma_f32 v[28:29], v[28:29], v[24:25], v[24:25] op_sel:[0,1,0] op_sel_hi:[1,1,0]
    v_pk_fma_f32 v[30:31], v[30:31], v[24:25], v[24:25] op_sel:[0,1,0] op_sel_hi:[1,1,0]
    v_pk_fma_f32 v[32:33], v[32:33], v[24:25], v[24:25] op_sel:[0,1,0] op_sel_hi:[1,1,0]
    v_pk_fma_f32 v[34:35], v[34:35], v[24:25], v[24:25] op_sel:[0,1,0] op_sel_hi:[1,1,0]
    v_pk_mul_f32 v[28:29], v[28:29], v[112:113]
    v_pk_mul_f32 v[30:31], v[30:31], v[114:115]
    v_pk_mul_f32 v[32:33], v[32:33], v[116:117]
    v_pk_mul_f32 v[34:35], v[34:35], v[118:119]
    v_exp_f32 v28, v28
    v_exp_f32 v30, v30
    v_exp_f32 v32, v32
    v_exp_f32 v34, v34
    v_exp_f32 v29, v29
    v_exp_f32 v31, v31
    v_pk_mul_f32 v[36:37], v[112:113], v[120:121]
    v_pk_fma_f32 v[28:29], v[28:29], v[26:27], v[26:27]
    v_pk_mul_f32 v[38:39], v[114:115], v[122:123]
    v_exp_f32 v33, v33
    v_exp_f32 v35, v35
    v_rcp_f32 v28, v28
    v_pk_mul_f32 v[40:41], v[116:117], v[124:125]
    v_pk_mul_f32 v[42:43], v[118:119], v[126:127]
    v_rcp_f32 v29, v29
    s_nop 0
    v_pk_mul_f32 v[36:37], v[36:37], v[28:29]
    v_pk_fma_f32 v[30:31], v[30:31], v[26:27], v[26:27]
    v_pk_fma_f32 v[32:33], v[32:33], v[26:27], v[26:27]
    v_pk_fma_f32 v[34:35], v[34:35], v[26:27], v[26:27]
    v_cvt_pk_bf16_f32 v16, v36, v37
    v_rcp_f32 v30, v30
    v_rcp_f32 v32, v32
    v_rcp_f32 v34, v34
    v_rcp_f32 v31, v31
    v_rcp_f32 v33, v33
    v_rcp_f32 v35, v35
    v_pk_mul_f32 v[38:39], v[38:39], v[30:31]
    v_pk_mul_f32 v[40:41], v[40:41], v[32:33]
    v_pk_mul_f32 v[42:43], v[42:43], v[34:35]
    v_cvt_pk_bf16_f32 v17, v38, v39
    v_cvt_pk_bf16_f32 v18, v40, v41
    v_cvt_pk_bf16_f32 v19, v42, v43
    buffer_store_dwordx4 v[16:19], v3, s[8:11], s57 offen offset:3072 sc1
    s_add_u32 s57, s57, 4096
    v_pk_mul_f32 v[28:29], v[128:129], v[128:129]
    v_pk_mul_f32 v[30:31], v[130:131], v[130:131]
    v_pk_mul_f32 v[32:33], v[132:133], v[132:133]
    v_pk_mul_f32 v[34:35], v[134:135], v[134:135]
    v_pk_fma_f32 v[28:29], v[28:29], v[24:25], v[24:25] op_sel:[0,1,0] op_sel_hi:[1,1,0]
    v_pk_fma_f32 v[30:31], v[30:31], v[24:25], v[24:25] op_sel:[0,1,0] op_sel_hi:[1,1,0]
    v_pk_fma_f32 v[32:33], v[32:33], v[24:25], v[24:25] op_sel:[0,1,0] op_sel_hi:[1,1,0]
    v_pk_fma_f32 v[34:35], v[34:35], v[24:25], v[24:25] op_sel:[0,1,0] op_sel_hi:[1,1,0]
    v_pk_mul_f32 v[28:29], v[28:29], v[128:129]
    v_pk_mul_f32 v[30:31], v[30:31], v[130:131]
    v_pk_mul_f32 v[32:33], v[32:33], v[132:133]
    v_pk_mul_f32 v[34:35], v[34:35], v[134:135]
    v_exp_f32 v28, v28
    v_exp_f32 v30, v30
    v_exp_f32 v32, v32
    v_exp_f32 v34, v34
    v_exp_f32 v29, v29
    v_exp_f32 v31, v31
    v_pk_mul_f32 v[36:37], v[128:129], v[136:137]
    v_pk_fma_f32 v[28:29], v[28:29], v[26:27], v[26:27]
    v_pk_mul_f32 v[38:39], v[130:131], v[138:139]
    v_exp_f32 v33, v33
    v_exp_f32 v35, v35
    v_rcp_f32 v28, v28
    v_pk_mul_f32 v[40:41], v[132:133], v[140:141]
    v_pk_mul_f32 v[42:43], v[134:135], v[142:143]
    v_rcp_f32 v29, v29
    s_nop 0
    v_pk_mul_f32 v[36:37], v[36:37], v[28:29]
    v_pk_fma_f32 v[30:31], v[30:31], v[26:27], v[26:27]
    v_pk_fma_f32 v[32:33], v[32:33], v[26:27], v[26:27]
    v_pk_fma_f32 v[34:35], v[34:35], v[26:27], v[26:27]
    v_cvt_pk_bf16_f32 v44, v36, v37
    v_rcp_f32 v30, v30
    v_rcp_f32 v32, v32
    v_rcp_f32 v34, v34
    v_rcp_f32 v31, v31
    v_rcp_f32 v33, v33
    v_rcp_f32 v35, v35
    v_pk_mul_f32 v[38:39], v[38:39], v[30:31]
    v_pk_mul_f32 v[40:41], v[40:41], v[32:33]
    v_pk_mul_f32 v[42:43], v[42:43], v[34:35]
    v_cvt_pk_bf16_f32 v45, v38, v39
    v_cvt_pk_bf16_f32 v46, v40, v41
    v_cvt_pk_bf16_f32 v47, v42, v43
    buffer_store_dwordx4 v[44:47], v3, s[8:11], s57 offen offset:0 sc1
    v_pk_mul_f32 v[28:29], v[144:145], v[144:145]
    v_pk_mul_f32 v[30:31], v[146:147], v[146:147]
    v_pk_mul_f32 v[32:33], v[148:149], v[148:149]
    v_pk_mul_f32 v[34:35], v[150:151], v[150:151]
    v_pk_fma_f32 v[28:29], v[28:29], v[24:25], v[24:25] op_sel:[0,1,0] op_sel_hi:[1,1,0]
    v_pk_fma_f32 v[30:31], v[30:31], v[24:25], v[24:25] op_sel:[0,1,0] op_sel_hi:[1,1,0]
    v_pk_fma_f32 v[32:33], v[32:33], v[24:25], v[24:25] op_sel:[0,1,0] op_sel_hi:[1,1,0]
    v_pk_fma_f32 v[34:35], v[34:35], v[24:25], v[24:25] op_sel:[0,1,0] op_sel_hi:[1,1,0]
    v_pk_mul_f32 v[28:29], v[28:29], v[144:145]
    v_pk_mul_f32 v[30:31], v[30:31], v[146:147]
    v_pk_mul_f32 v[32:33], v[32:33], v[148:149]
    v_pk_mul_f32 v[34:35], v[34:35], v[150:151]
    v_exp_f32 v28, v28
    v_exp_f32 v30, v30
    v_exp_f32 v32, v32
    v_exp_f32 v34, v34
    v_exp_f32 v29, v29
    v_exp_f32 v31, v31
    v_pk_mul_f32 v[36:37], v[144:145], v[152:153]
    v_pk_fma_f32 v[28:29], v[28:29], v[26:27], v[26:27]
    v_pk_mul_f32 v[38:39], v[146:147], v[154:155]
    v_exp_f32 v33, v33
    v_exp_f32 v35, v35
    v_rcp_f32 v28, v28
    v_pk_mul_f32 v[40:41], v[148:149], v[156:157]
    v_pk_mul_f32 v[42:43], v[150:151], v[158:159]
    v_rcp_f32 v29, v29
    s_nop 0
    v_pk_mul_f32 v[36:37], v[36:37], v[28:29]
    v_pk_fma_f32 v[30:31], v[30:31], v[26:27], v[26:27]
    v_pk_fma_f32 v[32:33], v[32:33], v[26:27], v[26:27]
    v_pk_fma_f32 v[34:35], v[34:35], v[26:27], v[26:27]
    v_cvt_pk_bf16_f32 v16, v36, v37
    v_rcp_f32 v30, v30
    v_rcp_f32 v32, v32
    v_rcp_f32 v34, v34
    v_rcp_f32 v31, v31
    v_rcp_f32 v33, v33
    v_rcp_f32 v35, v35
    v_pk_mul_f32 v[38:39], v[38:39], v[30:31]
    v_pk_mul_f32 v[40:41], v[40:41], v[32:33]
    v_pk_mul_f32 v[42:43], v[42:43], v[34:35]
    v_cvt_pk_bf16_f32 v17, v38, v39
    v_cvt_pk_bf16_f32 v18, v40, v41
    v_cvt_pk_bf16_f32 v19, v42, v43
    buffer_store_dwordx4 v[16:19], v3, s[8:11], s57 offen offset:1024 sc1
    v_pk_mul_f32 v[28:29], v[160:161], v[160:161]
    v_pk_mul_f32 v[30:31], v[162:163], v[162:163]
    v_pk_mul_f32 v[32:33], v[164:165], v[164:165]
    v_pk_mul_f32 v[34:35], v[166:167], v[166:167]
    v_pk_fma_f32 v[28:29], v[28:29], v[24:25], v[24:25] op_sel:[0,1,0] op_sel_hi:[1,1,0]
    v_pk_fma_f32 v[30:31], v[30:31], v[24:25], v[24:25] op_sel:[0,1,0] op_sel_hi:[1,1,0]
    v_pk_fma_f32 v[32:33], v[32:33], v[24:25], v[24:25] op_sel:[0,1,0] op_sel_hi:[1,1,0]
    v_pk_fma_f32 v[34:35], v[34:35], v[24:25], v[24:25] op_sel:[0,1,0] op_sel_hi:[1,1,0]
    v_pk_mul_f32 v[28:29], v[28:29], v[160:161]
    v_pk_mul_f32 v[30:31], v[30:31], v[162:163]
    v_pk_mul_f32 v[32:33], v[32:33], v[164:165]
    v_pk_mul_f32 v[34:35], v[34:35], v[166:167]
    v_exp_f32 v28, v28
    v_exp_f32 v30, v30
    v_exp_f32 v32, v32
    v_exp_f32 v34, v34
    v_exp_f32 v29, v29
    v_exp_f32 v31, v31
    v_pk_mul_f32 v[36:37], v[160:161], v[168:169]
    v_pk_fma_f32 v[28:29], v[28:29], v[26:27], v[26:27]
    v_pk_mul_f32 v[38:39], v[162:163], v[170:171]
    v_exp_f32 v33, v33
    v_exp_f32 v35, v35
    v_rcp_f32 v28, v28
    v_pk_mul_f32 v[40:41], v[164:165], v[172:173]
    v_pk_mul_f32 v[42:43], v[166:167], v[174:175]
    v_rcp_f32 v29, v29
    s_nop 0
    v_pk_mul_f32 v[36:37], v[36:37], v[28:29]
    v_pk_fma_f32 v[30:31], v[30:31], v[26:27], v[26:27]
    v_pk_fma_f32 v[32:33], v[32:33], v[26:27], v[26:27]
    v_pk_fma_f32 v[34:35], v[34:35], v[26:27], v[26:27]
    v_cvt_pk_bf16_f32 v44, v36, v37
    v_rcp_f32 v30, v30
    v_rcp_f32 v32, v32
    v_rcp_f32 v34, v34
    v_rcp_f32 v31, v31
    v_rcp_f32 v33, v33
    v_rcp_f32 v35, v35
    v_pk_mul_f32 v[38:39], v[38:39], v[30:31]
    v_pk_mul_f32 v[40:41], v[40:41], v[32:33]
    v_pk_mul_f32 v[42:43], v[42:43], v[34:35]
    v_cvt_pk_bf16_f32 v45, v38, v39
    v_cvt_pk_bf16_f32 v46, v40, v41
    v_cvt_pk_bf16_f32 v47, v42, v43
    buffer_store_dwordx4 v[44:47], v3, s[8:11], s57 offen offset:2048 sc1
    s_mul_i32 s64, s20, 32768
    s_lshl_b32 s65, s18, 11
    s_add_u32 s64, s64, s65
    s_add_u32 s64, s64, 0x500000
    v_lshlrev_b32 v6, 10, v4
    v_lshl_add_u32 v6, v5, 2, v6
    v_lshlrev_b32 v7, 6, v4
    s_lshl_b32 s65, s18, 7
    s_add_u32 s65, s65, 0x1c000
    v_lshlrev_b32 v8, 10, v5
    v_lshl_add_u32 v8, v4, 5, v8
    s_lshl_b32 s66, s20, 15
    s_lshl_b32 s67, s18, 6
    s_add_u32 s66, s66, s67
    s_mov_b32 s12, s42
    s_mov_b32 s13, s43
    s_mov_b32 s14, 0x200000
    s_mov_b32 s15, 0x20000
    s_mul_i32 s5, s51, 6144
    s_add_u32 s5, s5, 7168
    v_add_u32 v13, s5, v3
    v_add_u32 v14, 0x10000, v13
    s_xor_b32 s68, s51, 1
    s_mul_i32 s68, s68, 12288
    s_add_u32 s68, s68, 0
    v_add_u32 v9, s68, v3
    s_xor_b32 s68, s51, 2
    s_mul_i32 s68, s68, 12288
    s_add_u32 s68, s68, 4096
    v_add_u32 v10, s68, v3
    s_xor_b32 s68, s51, 3
    s_mul_i32 s68, s68, 12288
    s_add_u32 s68, s68, 8192
    v_add_u32 v11, s68, v3
    s_mul_i32 s68, s51, 12288
    v_add_u32 v12, s68, v3
    s_lshl_b32 s5, s48, 8
    s_lshr_b32 s6, s51, 1
    s_lshl_b32 s6, s6, 7
    s_add_u32 s5, s5, s6
    s_lshl_b32 s6, s49, 3
    s_add_u32 s5, s5, s6
    s_and_b32 s6, s51, 1
    s_lshl_b32 s6, s6, 2
    s_add_u32 s5, s5, s6
    s_add_u32 s5, s5, 0x1d000
    v_mov_b32 v40, 1
    v_mov_b32 v41, 0
    s_waitcnt vmcnt(0)
    s_mov_b64 exec, 1
    buffer_store_dword v40, v41, s[8:11], s5 offen sc1
    s_mov_b64 exec, -1
    s_barrier
    v_add_u32 v15, 0x20000, v13
    s_add_u32 s68, s24, 18432
    s_add_u32 s69, s25, 18432
    buffer_load_dwordx4 v[128:131], v3, s[8:11], s68 offen
    buffer_load_dwordx4 v[132:135], v3, s[8:11], s69 offen
    s_add_u32 s68, s24, 19456
    s_add_u32 s69, s25, 19456
    buffer_load_dwordx4 v[136:139], v3, s[8:11], s68 offen
    buffer_load_dwordx4 v[140:143], v3, s[8:11], s69 offen
    s_add_u32 s68, s24, 20480
    s_add_u32 s69, s25, 20480
    buffer_load_dwordx4 v[144:147], v3, s[8:11], s68 offen
    buffer_load_dwordx4 v[148:151], v3, s[8:11], s69 offen
    s_add_u32 s68, s24, 21504
    s_add_u32 s69, s25, 21504
    buffer_load_dwordx4 v[152:155], v3, s[8:11], s68 offen
    buffer_load_dwordx4 v[156:159], v3, s[8:11], s69 offen
    s_add_u32 s68, s24, 22528
    s_add_u32 s69, s25, 22528
    buffer_load_dwordx4 v[160:163], v3, s[8:11], s68 offen
    buffer_load_dwordx4 v[164:167], v3, s[8:11], s69 offen
    s_add_u32 s68, s24, 23552
    s_add_u32 s69, s25, 23552
    buffer_load_dwordx4 v[168:171], v3, s[8:11], s68 offen
    buffer_load_dwordx4 v[172:175], v3, s[8:11], s69 offen
    buffer_load_dword v16, v6, s[8:11], s64 offen offset:0
    buffer_load_dword v17, v6, s[8:11], s64 offen offset:128
    buffer_load_dword v18, v6, s[8:11], s64 offen offset:256
    buffer_load_dword v19, v6, s[8:11], s64 offen offset:384
    buffer_load_dword v20, v6, s[8:11], s64 offen offset:512
    buffer_load_dword v21, v6, s[8:11], s64 offen offset:640
    buffer_load_dword v22, v6, s[8:11], s64 offen offset:768
    buffer_load_dword v23, v6, s[8:11], s64 offen offset:896
    buffer_load_dwordx4 v[24:27], v7, s[8:11], s65 offen offset:0
    buffer_load_dwordx4 v[28:31], v7, s[8:11], s65 offen offset:16
    buffer_load_dwordx4 v[32:35], v7, s[8:11], s65 offen offset:32
    buffer_load_dwordx4 v[36:39], v7, s[8:11], s65 offen offset:48
    ds_read_b128 a[64:67], v14 offset:32768
    ds_read_b128 a[68:71], v14 offset:35840
    ds_read_b128 a[72:75], v14 offset:33792
    ds_read_b128 a[76:79], v14 offset:36864
    s_barrier
    s_add_u32 s68, s26, 18432
    s_add_u32 s69, s27, 18432
    buffer_load_dwordx4 v[64:67], v3, s[8:11], s68 offen sc1
    buffer_load_dwordx4 v[68:71], v3, s[8:11], s69 offen sc1
    s_add_u32 s68, s26, 19456
    s_add_u32 s69, s27, 19456
    buffer_load_dwordx4 v[72:75], v3, s[8:11], s68 offen sc1
    buffer_load_dwordx4 v[76:79], v3, s[8:11], s69 offen sc1
    s_add_u32 s68, s26, 20480
    s_add_u32 s69, s27, 20480
    buffer_load_dwordx4 v[80:83], v3, s[8:11], s68 offen sc1
    buffer_load_dwordx4 v[84:87], v3, s[8:11], s69 offen sc1
    s_add_u32 s68, s26, 21504
    s_add_u32 s69, s27, 21504
    buffer_load_dwordx4 v[88:91], v3, s[8:11], s68 offen sc1
    buffer_load_dwordx4 v[92:95], v3, s[8:11], s69 offen sc1
    s_add_u32 s68, s26, 22528
    s_add_u32 s69, s27, 22528
    buffer_load_dwordx4 v[96:99], v3, s[8:11], s68 offen sc1
    buffer_load_dwordx4 v[100:103], v3, s[8:11], s69 offen sc1
    s_add_u32 s68, s26, 23552
    s_add_u32 s69, s27, 23552
    buffer_load_dwordx4 v[104:107], v3, s[8:11], s68 offen sc1
    buffer_load_dwordx4 v[108:111], v3, s[8:11], s69 offen sc1
    s_add_u32 s68, s26, 0
    s_add_u32 s69, s27, 0
    buffer_load_dwordx4 v[112:115], v3, s[8:11], s68 offen sc1
    buffer_load_dwordx4 v[116:119], v3, s[8:11], s69 offen sc1
    s_add_u32 s68, s26, 1024
    s_add_u32 s69, s27, 1024
    buffer_load_dwordx4 v[120:123], v3, s[8:11], s68 offen sc1
    buffer_load_dwordx4 v[124:127], v3, s[8:11], s69 offen sc1
    s_waitcnt vmcnt(14)
    s_waitcnt vmcnt(38)
    v_mfma_f32_32x32x16_bf16 a[0:15], v[128:131], v[64:67], 0
    v_mfma_f32_32x32x16_bf16 a[16:31], v[128:131], v[68:71], 0
    v_mfma_f32_32x32x16_bf16 a[32:47], v[132:135], v[64:67], 0
    v_mfma_f32_32x32x16_bf16 a[48:63], v[132:135], v[68:71], 0
    s_add_u32 s68, s24, 24576
    s_add_u32 s69, s25, 24576
    buffer_load_dwordx4 v[128:131], v3, s[8:11], s68 offen
    buffer_load_dwordx4 v[132:135], v3, s[8:11], s69 offen
    s_add_u32 s68, s26, 2048
    s_add_u32 s69, s27, 2048
    buffer_load_dwordx4 v[64:67], v3, s[8:11], s68 offen sc1
    buffer_load_dwordx4 v[68:71], v3, s[8:11], s69 offen sc1
    s_waitcnt vmcnt(16)
    s_waitcnt vmcnt(40)
    v_mfma_f32_32x32x16_bf16 a[0:15], v[136:139], v[72:75], a[0:15]
    v_mfma_f32_32x32x16_bf16 a[16:31], v[136:139], v[76:79], a[16:31]
    v_mfma_f32_32x32x16_bf16 a[32:47], v[140:143], v[72:75], a[32:47]
    v_mfma_f32_32x32x16_bf16 a[48:63], v[140:143], v[76:79], a[48:63]
    s_add_u32 s68, s24, 25600
    s_add_u32 s69, s25, 25600
    buffer_load_dwordx4 v[136:139], v3, s[8:11], s68 offen
    buffer_load_dwordx4 v[140:143], v3, s[8:11], s69 offen
    s_add_u32 s68, s26, 3072
    s_add_u32 s69, s27, 3072
    buffer_load_dwordx4 v[72:75], v3, s[8:11], s68 offen sc1
    buffer_load_dwordx4 v[76:79], v3, s[8:11], s69 offen sc1
    s_waitcnt vmcnt(18)
    s_waitcnt vmcnt(42)
    v_mfma_f32_32x32x16_bf16 a[0:15], v[144:147], v[80:83], a[0:15]
    v_mfma_f32_32x32x16_bf16 a[16:31], v[144:147], v[84:87], a[16:31]
    v_mfma_f32_32x32x16_bf16 a[32:47], v[148:151], v[80:83], a[32:47]
    v_mfma_f32_32x32x16_bf16 a[48:63], v[148:151], v[84:87], a[48:63]
    s_add_u32 s68, s24, 26624
    s_add_u32 s69, s25, 26624
    buffer_load_dwordx4 v[144:147], v3, s[8:11], s68 offen
    buffer_load_dwordx4 v[148:151], v3, s[8:11], s69 offen
    s_add_u32 s68, s26, 4096
    s_add_u32 s69, s27, 4096
    buffer_load_dwordx4 v[80:83], v3, s[8:11], s68 offen sc1
    buffer_load_dwordx4 v[84:87], v3, s[8:11], s69 offen sc1
    s_waitcnt vmcnt(20)
    s_waitcnt vmcnt(44)
    v_mfma_f32_32x32x16_bf16 a[0:15], v[152:155], v[88:91], a[0:15]
    v_mfma_f32_32x32x16_bf16 a[16:31], v[152:155], v[92:95], a[16:31]
    v_mfma_f32_32x32x16_bf16 a[32:47], v[156:159], v[88:91], a[32:47]
    v_mfma_f32_32x32x16_bf16 a[48:63], v[156:159], v[92:95], a[48:63]
    s_add_u32 s68, s24, 27648
    s_add_u32 s69, s25, 27648
    buffer_load_dwordx4 v[152:155], v3, s[8:11], s68 offen
    buffer_load_dwordx4 v[156:159], v3, s[8:11], s69 offen
    s_add_u32 s68, s26, 5120
    s_add_u32 s69, s27, 5120
    buffer_load_dwordx4 v[88:91], v3, s[8:11], s68 offen sc1
    buffer_load_dwordx4 v[92:95], v3, s[8:11], s69 offen sc1
    s_waitcnt vmcnt(22)
    s_waitcnt vmcnt(46)
    v_mfma_f32_32x32x16_bf16 a[0:15], v[160:163], v[96:99], a[0:15]
    v_mfma_f32_32x32x16_bf16 a[16:31], v[160:163], v[100:103], a[16:31]
    v_mfma_f32_32x32x16_bf16 a[32:47], v[164:167], v[96:99], a[32:47]
    v_mfma_f32_32x32x16_bf16 a[48:63], v[164:167], v[100:103], a[48:63]
    s_add_u32 s68, s26, 6144
    s_add_u32 s69, s27, 6144
    buffer_load_dwordx4 v[96:99], v3, s[8:11], s68 offen sc1
    buffer_load_dwordx4 v[100:103], v3, s[8:11], s69 offen sc1
    s_waitcnt vmcnt(22)
    s_waitcnt vmcnt(46)
    v_mfma_f32_32x32x16_bf16 a[0:15], v[168:171], v[104:107], a[0:15]
    v_mfma_f32_32x32x16_bf16 a[16:31], v[168:171], v[108:111], a[16:31]
    v_mfma_f32_32x32x16_bf16 a[32:47], v[172:175], v[104:107], a[32:47]
    v_mfma_f32_32x32x16_bf16 a[48:63], v[172:175], v[108:111], a[48:63]
    s_add_u32 s68, s26, 7168
    s_add_u32 s69, s27, 7168
    buffer_load_dwordx4 v[104:107], v3, s[8:11], s68 offen sc1
    buffer_load_dwordx4 v[108:111], v3, s[8:11], s69 offen sc1
    s_waitcnt vmcnt(22)
    s_waitcnt lgkmcnt(2)
    v_mfma_f32_32x32x16_bf16 a[0:15], a[64:67], v[112:115], a[0:15]
    v_mfma_f32_32x32x16_bf16 a[16:31], a[64:67], v[116:119], a[16:31]
    v_mfma_f32_32x32x16_bf16 a[32:47], a[68:71], v[112:115], a[32:47]
    v_mfma_f32_32x32x16_bf16 a[48:63], a[68:71], v[116:119], a[48:63]
    ds_read_b128 a[64:67], v14 offset:34816
    ds_read_b128 a[68:71], v14 offset:37888
    s_add_u32 s68, s26, 8192
    s_add_u32 s69, s27, 8192
    buffer_load_dwordx4 v[112:115], v3, s[8:11], s68 offen sc1
    buffer_load_dwordx4 v[116:119], v3, s[8:11], s69 offen sc1
    s_waitcnt vmcnt(22)
    s_waitcnt lgkmcnt(2)
    v_mfma_f32_32x32x16_bf16 a[0:15], a[72:75], v[120:123], a[0:15]
    v_mfma_f32_32x32x16_bf16 a[16:31], a[72:75], v[124:127], a[16:31]
    v_mfma_f32_32x32x16_bf16 a[32:47], a[76:79], v[120:123], a[32:47]
    v_mfma_f32_32x32x16_bf16 a[48:63], a[76:79], v[124:127], a[48:63]
    ds_read_b128 a[72:75], v14 offset:57344
    ds_read_b128 a[76:79], v14 offset:60416
    s_add_u32 s68, s26, 9216
    s_add_u32 s69, s27, 9216
    buffer_load_dwordx4 v[120:123], v3, s[8:11], s68 offen sc1
    buffer_load_dwordx4 v[124:127], v3, s[8:11], s69 offen sc1
    s_waitcnt vmcnt(20)
    s_waitcnt lgkmcnt(2)
    v_mfma_f32_32x32x16_bf16 a[0:15], a[64:67], v[64:67], a[0:15]
    v_mfma_f32_32x32x16_bf16 a[16:31], a[64:67], v[68:71], a[16:31]
    v_mfma_f32_32x32x16_bf16 a[32:47], a[68:71], v[64:67], a[32:47]
    v_mfma_f32_32x32x16_bf16 a[48:63], a[68:71], v[68:71], a[48:63]
    ds_read_b128 a[64:67], v14 offset:58368
    ds_read_b128 a[68:71], v14 offset:61440
    s_add_u32 s68, s26, 10240
    s_add_u32 s69, s27, 10240
    buffer_load_dwordx4 v[64:67], v3, s[8:11], s68 offen sc1
    buffer_load_dwordx4 v[68:71], v3, s[8:11], s69 offen sc1
    s_waitcnt vmcnt(18)
    s_waitcnt lgkmcnt(2)
    v_mfma_f32_32x32x16_bf16 a[0:15], a[72:75], v[72:75], a[0:15]
    v_mfma_f32_32x32x16_bf16 a[16:31], a[72:75], v[76:79], a[16:31]
    v_mfma_f32_32x32x16_bf16 a[32:47], a[76:79], v[72:75], a[32:47]
    v_mfma_f32_32x32x16_bf16 a[48:63], a[76:79], v[76:79], a[48:63]
    ds_read_b128 a[72:75], v14 offset:59392
    ds_read_b128 a[76:79], v14 offset:62464
    s_add_u32 s68, s26, 11264
    s_add_u32 s69, s27, 11264
    buffer_load_dwordx4 v[72:75], v3, s[8:11], s68 offen sc1
    buffer_load_dwordx4 v[76:79], v3, s[8:11], s69 offen sc1
    s_waitcnt vmcnt(16)
    s_waitcnt lgkmcnt(2)
    v_mfma_f32_32x32x16_bf16 a[0:15], a[64:67], v[80:83], a[0:15]
    v_mfma_f32_32x32x16_bf16 a[16:31], a[64:67], v[84:87], a[16:31]
    v_mfma_f32_32x32x16_bf16 a[32:47], a[68:71], v[80:83], a[32:47]
    v_mfma_f32_32x32x16_bf16 a[48:63], a[68:71], v[84:87], a[48:63]
    ds_read_b128 a[64:67], v13 offset:0
    ds_read_b128 a[68:71], v13 offset:3072
    s_add_u32 s68, s26, 12288
    s_add_u32 s69, s27, 12288
    buffer_load_dwordx4 v[80:83], v3, s[8:11], s68 offen sc1
    buffer_load_dwordx4 v[84:87], v3, s[8:11], s69 offen sc1
    s_waitcnt vmcnt(14)
    s_waitcnt lgkmcnt(2)
    v_mfma_f32_32x32x16_bf16 a[0:15], a[72:75], v[88:91], a[0:15]
    v_mfma_f32_32x32x16_bf16 a[16:31], a[72:75], v[92:95], a[16:31]
    v_mfma_f32_32x32x16_bf16 a[32:47], a[76:79], v[88:91], a[32:47]
    v_mfma_f32_32x32x16_bf16 a[48:63], a[76:79], v[92:95], a[48:63]
    ds_read_b128 a[72:75], v13 offset:1024
    ds_read_b128 a[76:79], v13 offset:4096
    s_add_u32 s68, s26, 13312
    s_add_u32 s69, s27, 13312
    buffer_load_dwordx4 v[88:91], v3, s[8:11], s68 offen sc1
    buffer_load_dwordx4 v[92:95], v3, s[8:11], s69 offen sc1
    s_waitcnt vmcnt(14)
    s_waitcnt lgkmcnt(2)
    v_mfma_f32_32x32x16_bf16 a[0:15], a[64:67], v[96:99], a[0:15]
    v_mfma_f32_32x32x16_bf16 a[16:31], a[64:67], v[100:103], a[16:31]
    v_mfma_f32_32x32x16_bf16 a[32:47], a[68:71], v[96:99], a[32:47]
    v_mfma_f32_32x32x16_bf16 a[48:63], a[68:71], v[100:103], a[48:63]
    ds_read_b128 a[64:67], v13 offset:2048
    ds_read_b128 a[68:71], v13 offset:5120
    s_add_u32 s68, s26, 14336
    s_add_u32 s69, s27, 14336
    buffer_load_dwordx4 v[96:99], v3, s[8:11], s68 offen sc1
    buffer_load_dwordx4 v[100:103], v3, s[8:11], s69 offen sc1
    s_waitcnt vmcnt(14)
    s_waitcnt lgkmcnt(2)
    v_mfma_f32_32x32x16_bf16 a[0:15], a[72:75], v[104:107], a[0:15]
    v_mfma_f32_32x32x16_bf16 a[16:31], a[72:75], v[108:111], a[16:31]
    v_mfma_f32_32x32x16_bf16 a[32:47], a[76:79], v[104:107], a[32:47]
    v_mfma_f32_32x32x16_bf16 a[48:63], a[76:79], v[108:111], a[48:63]
    ds_read_b128 a[72:75], v13 offset:24576
    ds_read_b128 a[76:79], v13 offset:27648
    s_add_u32 s68, s26, 15360
    s_add_u32 s69, s27, 15360
    buffer_load_dwordx4 v[104:107], v3, s[8:11], s68 offen sc1
    buffer_load_dwordx4 v[108:111], v3, s[8:11], s69 offen sc1
    s_waitcnt vmcnt(14)
    s_waitcnt lgkmcnt(2)
    v_mfma_f32_32x32x16_bf16 a[0:15], a[64:67], v[112:115], a[0:15]
    v_mfma_f32_32x32x16_bf16 a[16:31], a[64:67], v[116:119], a[16:31]
    v_mfma_f32_32x32x16_bf16 a[32:47], a[68:71], v[112:115], a[32:47]
    v_mfma_f32_32x32x16_bf16 a[48:63], a[68:71], v[116:119], a[48:63]
    ds_read_b128 a[64:67], v13 offset:25600
    ds_read_b128 a[68:71], v13 offset:28672
    s_add_u32 s68, s26, 16384
    s_add_u32 s69, s27, 16384
    buffer_load_dwordx4 v[112:115], v3, s[8:11], s68 offen sc1
    buffer_load_dwordx4 v[116:119], v3, s[8:11], s69 offen sc1
    s_waitcnt vmcnt(14)
    s_waitcnt lgkmcnt(2)
    v_mfma_f32_32x32x16_bf16 a[0:15], a[72:75], v[120:123], a[0:15]
    v_mfma_f32_32x32x16_bf16 a[16:31], a[72:75], v[124:127], a[16:31]
    v_mfma_f32_32x32x16_bf16 a[32:47], a[76:79], v[120:123], a[32:47]
    v_mfma_f32_32x32x16_bf16 a[48:63], a[76:79], v[124:127], a[48:63]
    ds_read_b128 a[72:75], v13 offset:26624
    ds_read_b128 a[76:79], v13 offset:29696
    s_add_u32 s68, s26, 17408
    s_add_u32 s69, s27, 17408
    buffer_load_dwordx4 v[120:123], v3, s[8:11], s68 offen sc1
    buffer_load_dwordx4 v[124:127], v3, s[8:11], s69 offen sc1
    s_waitcnt vmcnt(14)
    s_waitcnt lgkmcnt(2)
    v_mfma_f32_32x32x16_bf16 a[0:15], a[64:67], v[64:67], a[0:15]
    v_mfma_f32_32x32x16_bf16 a[16:31], a[64:67], v[68:71], a[16:31]
    v_mfma_f32_32x32x16_bf16 a[32:47], a[68:71], v[64:67], a[32:47]
    v_mfma_f32_32x32x16_bf16 a[48:63], a[68:71], v[68:71], a[48:63]
    ds_read_b128 a[64:67], v13 offset:49152
    ds_read_b128 a[68:71], v13 offset:52224
    s_add_u32 s68, s26, 24576
    s_add_u32 s69, s27, 24576
    buffer_load_dwordx4 v[64:67], v3, s[8:11], s68 offen sc1
    buffer_load_dwordx4 v[68:71], v3, s[8:11], s69 offen sc1
    s_waitcnt vmcnt(14)
    s_waitcnt lgkmcnt(2)
    v_mfma_f32_32x32x16_bf16 a[0:15], a[72:75], v[72:75], a[0:15]
    v_mfma_f32_32x32x16_bf16 a[16:31], a[72:75], v[76:79], a[16:31]
    v_mfma_f32_32x32x16_bf16 a[32:47], a[76:79], v[72:75], a[32:47]
    v_mfma_f32_32x32x16_bf16 a[48:63], a[76:79], v[76:79], a[48:63]
    ds_read_b128 a[72:75], v13 offset:50176
    ds_read_b128 a[76:79], v13 offset:53248
    s_add_u32 s68, s26, 25600
    s_add_u32 s69, s27, 25600
    buffer_load_dwordx4 v[72:75], v3, s[8:11], s68 offen sc1
    buffer_load_dwordx4 v[76:79], v3, s[8:11], s69 offen sc1
    s_waitcnt vmcnt(14)
    s_waitcnt lgkmcnt(2)
    v_mfma_f32_32x32x16_bf16 a[0:15], a[64:67], v[80:83], a[0:15]
    v_mfma_f32_32x32x16_bf16 a[16:31], a[64:67], v[84:87], a[16:31]
    v_mfma_f32_32x32x16_bf16 a[32:47], a[68:71], v[80:83], a[32:47]
    v_mfma_f32_32x32x16_bf16 a[48:63], a[68:71], v[84:87], a[48:63]
    ds_read_b128 a[64:67], v13 offset:51200
    ds_read_b128 a[68:71], v13 offset:54272
    s_add_u32 s68, s26, 26624
    s_add_u32 s69, s27, 26624
    buffer_load_dwordx4 v[80:83], v3, s[8:11], s68 offen sc1
    buffer_load_dwordx4 v[84:87], v3, s[8:11], s69 offen sc1
    s_waitcnt vmcnt(14)
    s_waitcnt lgkmcnt(2)
    v_mfma_f32_32x32x16_bf16 a[0:15], a[72:75], v[88:91], a[0:15]
    v_mfma_f32_32x32x16_bf16 a[16:31], a[72:75], v[92:95], a[16:31]
    v_mfma_f32_32x32x16_bf16 a[32:47], a[76:79], v[88:91], a[32:47]
    v_mfma_f32_32x32x16_bf16 a[48:63], a[76:79], v[92:95], a[48:63]
    ds_read_b128 a[72:75], v14 offset:8192
    ds_read_b128 a[76:79], v14 offset:11264
    s_add_u32 s68, s26, 27648
    s_add_u32 s69, s27, 27648
    buffer_load_dwordx4 v[88:91], v3, s[8:11], s68 offen sc1
    buffer_load_dwordx4 v[92:95], v3, s[8:11], s69 offen sc1
    s_waitcnt vmcnt(14)
    s_waitcnt lgkmcnt(2)
    v_mfma_f32_32x32x16_bf16 a[0:15], a[64:67], v[96:99], a[0:15]
    v_mfma_f32_32x32x16_bf16 a[16:31], a[64:67], v[100:103], a[16:31]
    v_mfma_f32_32x32x16_bf16 a[32:47], a[68:71], v[96:99], a[32:47]
    v_mfma_f32_32x32x16_bf16 a[48:63], a[68:71], v[100:103], a[48:63]
    ds_read_b128 a[64:67], v14 offset:9216
    ds_read_b128 a[68:71], v14 offset:12288
    s_waitcnt vmcnt(12)
    s_waitcnt lgkmcnt(2)
    v_mfma_f32_32x32x16_bf16 a[0:15], a[72:75], v[104:107], a[0:15]
    v_mfma_f32_32x32x16_bf16 a[16:31], a[72:75], v[108:111], a[16:31]
    v_mfma_f32_32x32x16_bf16 a[32:47], a[76:79], v[104:107], a[32:47]
    v_mfma_f32_32x32x16_bf16 a[48:63], a[76:79], v[108:111], a[48:63]
    ds_read_b128 a[72:75], v14 offset:10240
    ds_read_b128 a[76:79], v14 offset:13312
    s_waitcnt vmcnt(10)
    s_waitcnt lgkmcnt(2)
    v_mfma_f32_32x32x16_bf16 a[0:15], a[64:67], v[112:115], a[0:15]
    v_mfma_f32_32x32x16_bf16 a[16:31], a[64:67], v[116:119], a[16:31]
    v_mfma_f32_32x32x16_bf16 a[32:47], a[68:71], v[112:115], a[32:47]
    v_mfma_f32_32x32x16_bf16 a[48:63], a[68:71], v[116:119], a[48:63]
    s_waitcnt vmcnt(8)
    s_waitcnt lgkmcnt(0)
    v_mfma_f32_32x32x16_bf16 a[0:15], a[72:75], v[120:123], a[0:15]
    v_mfma_f32_32x32x16_bf16 a[16:31], a[72:75], v[124:127], a[16:31]
    v_mfma_f32_32x32x16_bf16 a[32:47], a[76:79], v[120:123], a[32:47]
    v_mfma_f32_32x32x16_bf16 a[48:63], a[76:79], v[124:127], a[48:63]
    s_barrier
    s_waitcnt vmcnt(6)
    s_waitcnt vmcnt(46)
    v_mfma_f32_32x32x16_bf16 a[0:15], v[128:131], v[64:67], a[0:15]
    v_mfma_f32_32x32x16_bf16 a[16:31], v[128:131], v[68:71], a[16:31]
    v_mfma_f32_32x32x16_bf16 a[32:47], v[132:135], v[64:67], a[32:47]
    v_mfma_f32_32x32x16_bf16 a[48:63], v[132:135], v[68:71], a[48:63]
    s_waitcnt vmcnt(4)
    s_waitcnt vmcnt(42)
    v_mfma_f32_32x32x16_bf16 a[0:15], v[136:139], v[72:75], a[0:15]
    v_mfma_f32_32x32x16_bf16 a[16:31], v[136:139], v[76:79], a[16:31]
    v_mfma_f32_32x32x16_bf16 a[32:47], v[140:143], v[72:75], a[32:47]
    v_mfma_f32_32x32x16_bf16 a[48:63], v[140:143], v[76:79], a[48:63]
    s_waitcnt vmcnt(2)
    s_waitcnt vmcnt(38)
    v_mfma_f32_32x32x16_bf16 a[0:15], v[144:147], v[80:83], a[0:15]
    v_mfma_f32_32x32x16_bf16 a[16:31], v[144:147], v[84:87], a[16:31]
    v_mfma_f32_32x32x16_bf16 a[32:47], v[148:151], v[80:83], a[32:47]
    v_mfma_f32_32x32x16_bf16 a[48:63], v[148:151], v[84:87], a[48:63]
    s_waitcnt vmcnt(0)
    s_waitcnt vmcnt(34)
    v_mfma_f32_32x32x16_bf16 a[0:15], v[152:155], v[88:91], a[0:15]
    v_mfma_f32_32x32x16_bf16 a[16:31], v[152:155], v[92:95], a[16:31]
    v_mfma_f32_32x32x16_bf16 a[32:47], v[156:159], v[88:91], a[32:47]
    v_mfma_f32_32x32x16_bf16 a[48:63], v[156:159], v[92:95], a[48:63]
    s_nop 9
    ds_write_b128 v9, a[16:19] offset:0
    ds_write_b128 v9, a[20:23] offset:1024
    ds_write_b128 v9, a[24:27] offset:2048
    ds_write_b128 v9, a[28:31] offset:3072
    ds_write_b128 v10, a[32:35] offset:0
    ds_write_b128 v10, a[36:39] offset:1024
    ds_write_b128 v10, a[40:43] offset:2048
    ds_write_b128 v10, a[44:47] offset:3072
    ds_write_b128 v11, a[48:51] offset:0
    ds_write_b128 v11, a[52:55] offset:1024
    ds_write_b128 v11, a[56:59] offset:2048
    ds_write_b128 v11, a[60:63] offset:3072
    v_accvgpr_read_b32 v40, a0
    v_accvgpr_read_b32 v41, a1
    v_accvgpr_read_b32 v42, a2
    v_accvgpr_read_b32 v43, a3
    v_accvgpr_read_b32 v44, a4
    v_accvgpr_read_b32 v45, a5
    v_accvgpr_read_b32 v46, a6
    v_accvgpr_read_b32 v47, a7
    v_accvgpr_read_b32 v48, a8
    v_accvgpr_read_b32 v49, a9
    v_accvgpr_read_b32 v50, a10
    v_accvgpr_read_b32 v51, a11
    v_accvgpr_read_b32 v52, a12
    v_accvgpr_read_b32 v53, a13
    v_accvgpr_read_b32 v54, a14
    v_accvgpr_read_b32 v55, a15
    s_waitcnt lgkmcnt(0)
    s_barrier
    ds_read_b128 v[64:67], v12 offset:0
    ds_read_b128 v[68:71], v12 offset:1024
    ds_read_b128 v[72:75], v12 offset:2048
    ds_read_b128 v[76:79], v12 offset:3072
    ds_read_b128 v[80:83], v12 offset:4096
    ds_read_b128 v[84:87], v12 offset:5120
    ds_read_b128 v[88:91], v12 offset:6144
    ds_read_b128 v[92:95], v12 offset:7168
    ds_read_b128 v[96:99], v12 offset:8192
    ds_read_b128 v[100:103], v12 offset:9216
    ds_read_b128 v[104:107], v12 offset:10240
    ds_read_b128 v[108:111], v12 offset:11264
    s_waitcnt lgkmcnt(8)
    v_pk_add_f32 v[40:41], v[40:41], v[64:65]
    v_pk_add_f32 v[42:43], v[42:43], v[66:67]
    v_pk_add_f32 v[44:45], v[44:45], v[68:69]
    v_pk_add_f32 v[46:47], v[46:47], v[70:71]
    v_pk_add_f32 v[48:49], v[48:49], v[72:73]
    v_pk_add_f32 v[50:51], v[50:51], v[74:75]
    v_pk_add_f32 v[52:53], v[52:53], v[76:77]
    v_pk_add_f32 v[54:55], v[54:55], v[78:79]
    s_waitcnt lgkmcnt(4)
    v_pk_add_f32 v[40:41], v[40:41], v[80:81]
    v_pk_add_f32 v[42:43], v[42:43], v[82:83]
    v_pk_add_f32 v[44:45], v[44:45], v[84:85]
    v_pk_add_f32 v[46:47], v[46:47], v[86:87]
    v_pk_add_f32 v[48:49], v[48:49], v[88:89]
    v_pk_add_f32 v[50:51], v[50:51], v[90:91]
    v_pk_add_f32 v[52:53], v[52:53], v[92:93]
    v_pk_add_f32 v[54:55], v[54:55], v[94:95]
    s_waitcnt lgkmcnt(0)
    v_pk_add_f32 v[40:41], v[40:41], v[96:97]
    v_pk_add_f32 v[42:43], v[42:43], v[98:99]
    v_pk_add_f32 v[44:45], v[44:45], v[100:101]
    v_pk_add_f32 v[46:47], v[46:47], v[102:103]
    v_pk_add_f32 v[48:49], v[48:49], v[104:105]
    v_pk_add_f32 v[50:51], v[50:51], v[106:107]
    v_pk_add_f32 v[52:53], v[52:53], v[108:109]
    v_pk_add_f32 v[54:55], v[54:55], v[110:111]
    v_cvt_pk_bf16_f32 v56, v40, v41
    v_lshlrev_b32 v40, 16, v56
    v_and_b32 v41, 0xffff0000, v56
    v_pk_mul_f32 v[40:41], v[40:41], v[24:25]
    v_cvt_pk_bf16_f32 v57, v40, v41
    v_lshlrev_b32 v40, 16, v57
    v_and_b32 v41, 0xffff0000, v57
    v_lshlrev_b32 v58, 16, v16
    v_and_b32 v59, 0xffff0000, v16
    v_pk_add_f32 v[40:41], v[40:41], v[58:59]
    v_cvt_pk_bf16_f32 v64, v40, v41
    v_cvt_pk_bf16_f32 v56, v42, v43
    v_lshlrev_b32 v42, 16, v56
    v_and_b32 v43, 0xffff0000, v56
    v_pk_mul_f32 v[42:43], v[42:43], v[26:27]
    v_cvt_pk_bf16_f32 v57, v42, v43
    v_lshlrev_b32 v42, 16, v57
    v_and_b32 v43, 0xffff0000, v57
    v_lshlrev_b32 v58, 16, v17
    v_and_b32 v59, 0xffff0000, v17
    v_pk_add_f32 v[42:43], v[42:43], v[58:59]
    v_cvt_pk_bf16_f32 v65, v42, v43
    v_cvt_pk_bf16_f32 v56, v44, v45
    v_lshlrev_b32 v44, 16, v56
    v_and_b32 v45, 0xffff0000, v56
    v_pk_mul_f32 v[44:45], v[44:45], v[28:29]
    v_cvt_pk_bf16_f32 v57, v44, v45
    v_lshlrev_b32 v44, 16, v57
    v_and_b32 v45, 0xffff0000, v57
    v_lshlrev_b32 v58, 16, v18
    v_and_b32 v59, 0xffff0000, v18
    v_pk_add_f32 v[44:45], v[44:45], v[58:59]
    v_cvt_pk_bf16_f32 v66, v44, v45
    v_cvt_pk_bf16_f32 v56, v46, v47
    v_lshlrev_b32 v46, 16, v56
    v_and_b32 v47, 0xffff0000, v56
    v_pk_mul_f32 v[46:47], v[46:47], v[30:31]
    v_cvt_pk_bf16_f32 v57, v46, v47
    v_lshlrev_b32 v46, 16, v57
    v_and_b32 v47, 0xffff0000, v57
    v_lshlrev_b32 v58, 16, v19
    v_and_b32 v59, 0xffff0000, v19
    v_pk_add_f32 v[46:47], v[46:47], v[58:59]
    v_cvt_pk_bf16_f32 v67, v46, v47
    v_cvt_pk_bf16_f32 v56, v48, v49
    v_lshlrev_b32 v48, 16, v56
    v_and_b32 v49, 0xffff0000, v56
    v_pk_mul_f32 v[48:49], v[48:49], v[32:33]
    v_cvt_pk_bf16_f32 v57, v48, v49
    v_lshlrev_b32 v48, 16, v57
    v_and_b32 v49, 0xffff0000, v57
    v_lshlrev_b32 v58, 16, v20
    v_and_b32 v59, 0xffff0000, v20
    v_pk_add_f32 v[48:49], v[48:49], v[58:59]
    v_cvt_pk_bf16_f32 v68, v48, v49
    v_cvt_pk_bf16_f32 v56, v50, v51
    v_lshlrev_b32 v50, 16, v56
    v_and_b32 v51, 0xffff0000, v56
    v_pk_mul_f32 v[50:51], v[50:51], v[34:35]
    v_cvt_pk_bf16_f32 v57, v50, v51
    v_lshlrev_b32 v50, 16, v57
    v_and_b32 v51, 0xffff0000, v57
    v_lshlrev_b32 v58, 16, v21
    v_and_b32 v59, 0xffff0000, v21
    v_pk_add_f32 v[50:51], v[50:51], v[58:59]
    v_cvt_pk_bf16_f32 v69, v50, v51
    v_cvt_pk_bf16_f32 v56, v52, v53
    v_lshlrev_b32 v52, 16, v56
    v_and_b32 v53, 0xffff0000, v56
    v_pk_mul_f32 v[52:53], v[52:53], v[36:37]
    v_cvt_pk_bf16_f32 v57, v52, v53
    v_lshlrev_b32 v52, 16, v57
    v_and_b32 v53, 0xffff0000, v57
    v_lshlrev_b32 v58, 16, v22
    v_and_b32 v59, 0xffff0000, v22
    v_pk_add_f32 v[52:53], v[52:53], v[58:59]
    v_cvt_pk_bf16_f32 v70, v52, v53
    v_cvt_pk_bf16_f32 v56, v54, v55
    v_lshlrev_b32 v54, 16, v56
    v_and_b32 v55, 0xffff0000, v56
    v_pk_mul_f32 v[54:55], v[54:55], v[38:39]
    v_cvt_pk_bf16_f32 v57, v54, v55
    v_lshlrev_b32 v54, 16, v57
    v_and_b32 v55, 0xffff0000, v57
    v_lshlrev_b32 v58, 16, v23
    v_and_b32 v59, 0xffff0000, v23
    v_pk_add_f32 v[54:55], v[54:55], v[58:59]
    v_cvt_pk_bf16_f32 v71, v54, v55
    buffer_store_dwordx4 v[64:67], v8, s[12:15], s66 offen
    buffer_store_dwordx4 v[68:71], v8, s[12:15], s66 offen offset:16
ffn_kernel_end1:
    s_endpgm
code_end:
.section .rodata,"a"
.p2align 6
.amdhsa_kernel prep_kernel
  .amdhsa_next_free_vgpr 203
  .amdhsa_next_free_sgpr 90
  .amdhsa_accum_offset 204
  .amdhsa_group_segment_fixed_size 0
  .amdhsa_kernarg_size 128
  .amdhsa_user_sgpr_count 2
  .amdhsa_user_sgpr_kernarg_segment_ptr 1
  .amdhsa_system_sgpr_workgroup_id_x 1
  .amdhsa_float_denorm_mode_32 3
.end_amdhsa_kernel
.p2align 6
.amdhsa_kernel conv_kernel
  .amdhsa_next_free_vgpr 240
  .amdhsa_next_free_sgpr 98
  .amdhsa_accum_offset 240
  .amdhsa_group_segment_fixed_size 0
  .amdhsa_kernarg_size 128
  .amdhsa_user_sgpr_count 2
  .amdhsa_user_sgpr_kernarg_segment_ptr 1
  .amdhsa_system_sgpr_workgroup_id_x 1
  .amdhsa_float_denorm_mode_32 3
.end_amdhsa_kernel
.p2align 6
.amdhsa_kernel ffn_kernel
  .amdhsa_next_free_vgpr 256
  .amdhsa_next_free_sgpr 70
  .amdhsa_accum_offset 176
  .amdhsa_group_segment_fixed_size 0
  .amdhsa_kernarg_size 128
  .amdhsa_user_sgpr_count 2
  .amdhsa_user_sgpr_kernarg_segment_ptr 1
  .amdhsa_system_sgpr_workgroup_id_x 1
  .amdhsa_float_denorm_mode_32 3
.end_amdhsa_kernel
```
